```python
import torch

def _softmax(x, axis=-1):
    return torch.softmax(x, dim=axis)
def _gelu(x):
    return torch.nn.functional.gelu(x, approximate="tanh")
def _silu(x):
    return torch.nn.functional.silu(x)
def _sigmoid(x):
    return torch.sigmoid(x)
def _layernorm(x, axis=-1, eps=1e-5):
    m = x.mean(dim=axis, keepdim=True)
    v = x.var(dim=axis, keepdim=True, unbiased=False)
    return (x - m) / torch.sqrt(v + eps)
def _scatter_add(tgt, idx, src, axis=0):
    return tgt.clone().index_add_(axis, idx, src)
def _segment_sum(src, seg, n):
    out = torch.zeros((n,) + src.shape[1:], dtype=src.dtype)
    return out.index_add_(0, seg, src)
def _pad(x, pw):
    flat = tuple(v for pair in reversed(pw) for v in pair)
    return torch.nn.functional.pad(x, flat)

kernel_name = 'gated_mix__ssm_conv_h3__dense_activation_squared_relu__prompt'

def setup_inputs():

    _w = (lambda a: (lambda t: t.to(torch.bfloat16) if t.is_floating_point() else t)(torch.as_tensor(a)))
    def _A_setup():
        B, S, D = 1, 2048, 512
        ks = 4
        return {
            "q": _w((lambda *s: torch.randn(*s, dtype=torch.bfloat16) * 0.05)(B, S, D)),
            "k": _w((lambda *s: torch.randn(*s, dtype=torch.bfloat16) * 0.4)(B, S, D)),
            "v": _w((lambda *s: torch.randn(*s, dtype=torch.bfloat16) * 0.4)(B, S, D)),
            "shift_k": _w((lambda *s: torch.randn(*s, dtype=torch.bfloat16) * 0.4)(D, ks) * 0.5),
            "ssm_k": _w((lambda *s: torch.randn(*s, dtype=torch.bfloat16) * 1.6)(D, S) * (1.0 / S ** 0.5)),
            "ssm_D": _w((lambda *s: torch.randn(*s, dtype=torch.bfloat16) * 0.4)(D)),
        }
    _A_in = _A_setup()

    def _B_setup():
        B, S, D, F = 1, 2048, 512, 1792
        return {
            "x": _w((lambda *s: torch.randn(*s, dtype=torch.bfloat16) * 0.05)(B, S, D)),
            "w1": _w((lambda *s: torch.randn(*s, dtype=torch.bfloat16) * 0.05)(D, F)),
            "b1": _w((lambda *s: torch.randn(*s, dtype=torch.bfloat16) * 0.05)(F)),
            "w2": _w((lambda *s: torch.randn(*s, dtype=torch.bfloat16) * 0.05)(F, D)),
            "b2": _w((lambda *s: torch.randn(*s, dtype=torch.bfloat16) * 0.05)(D)),
        }
    _B_in = _B_setup()

    return {
        "A_q": _A_in["q"],
        "A_k": _A_in["k"],
        "A_v": _A_in["v"],
        "A_shift_k": _A_in["shift_k"],
        "A_ssm_k": _A_in["ssm_k"],
        "A_ssm_D": _A_in["ssm_D"],
        "B_x": _B_in["x"],
        "B_w1": _B_in["w1"],
        "B_b1": _B_in["b1"],
        "B_w2": _B_in["w2"],
        "B_b2": _B_in["b2"],
        "gate_w": _w((lambda *s: torch.randn(*s, dtype=torch.bfloat16) * 0.05)(512) * 16.0),
    }

def reference(A_q, A_k, A_v, A_shift_k, A_ssm_k, A_ssm_D, B_x, B_w1, B_b1, B_w2, B_b2, gate_w):
    def _A_ref(q, k, v, shift_k, ssm_k, ssm_D):
        B, S, D = q.shape
        ks = shift_k.shape[-1]
        k_pad = _pad(k, ((0, 0), (ks - 1, 0), (0, 0)))
        k_shift = torch.zeros_like(k)
        for t in range(ks):
            k_shift = k_shift + k_pad[:, t:t + S, :] * shift_k[:, ks - 1 - t][None, None, :]
        kv = k_shift * v
        L = 2 * S
        kv_pad = _pad(kv, ((0, 0), (0, S), (0, 0)))
        kf_pad = _pad(ssm_k, ((0, 0), (0, S)))
        kv_f = (lambda x, axes=(-2,-1): torch.fft.rfft2(x.float(), dim=axes))(kv_pad[:, None, :, :], axes=(1, 2))
        kf_f = (lambda x, axes=(-2,-1): torch.fft.rfft2(x.float(), dim=axes))(kf_pad[:, None, :], axes=(1, 2))
        kf_f = (lambda x, *d: x.permute(*d))(kf_f, 1, 2, 0)
        y_f = kv_f * kf_f[None, :, :, :]
        y = (lambda x, s, axes=(-2,-1): torch.fft.irfft2(x, s=s, dim=axes).to(torch.bfloat16))(y_f, (1, L), axes=(1, 2))[:, 0, :S, :]
        y = y + kv * ssm_D[None, None, :]
        return q * y

    def _B_ref(x, w1, b1, w2, b2):
        h = torch.einsum("bsd,df->bsf", x, w1) + b1
        zero = torch.zeros_like(h)
        r = torch.where(h > zero, h, zero)
        h = r * r
        out = torch.einsum("bsf,fd->bsd", h, w2) + b2
        return out

    x = A_q
    g = _sigmoid((x * gate_w).sum(-1, keepdims=True))
    a = _A_ref(x, A_k, A_v, A_shift_k, A_ssm_k, A_ssm_D)
    b = _B_ref(x, B_w1, B_b1, B_w2, B_b2)
    return g * a + (1 - g) * b
```

```asm
; @launch grid=(256,1,1) block=(256,1,1) lds=163840
.amdgcn_target "amdgcn-amd-amdhsa--gfx950"
.text
.globl gated_mix__ssm_conv_h3__dense_activation_squared_relu__prompt_kernel
.p2align 8
.type gated_mix__ssm_conv_h3__dense_activation_squared_relu__prompt_kernel,@function
gated_mix__ssm_conv_h3__dense_activation_squared_relu__prompt_kernel:
s_cmp_ge_u32 s2, 256
s_cbranch_scc1 K_END
s_load_dwordx16 s[44:59], s[0:1], 0
s_load_dwordx8 s[60:67], s[0:1], 64
s_load_dwordx4 s[68:71], s[0:1], 96
s_load_dwordx2 s[72:73], s[0:1], 112
v_lshrrev_b32 v1, 6, v0
s_nop 0
v_readfirstlane_b32 s4, v1
s_lshr_b32 s74, s2, 3
s_cmp_ge_u32 s74, 28
s_cbranch_scc1 GATE
s_and_b32 s74, s2, 7
s_lshr_b32 s75, s2, 3
s_lshr_b32 s5, s74, 1
s_lshl_b32 s5, s5, 2
s_and_b32 s76, s75, 3
s_add_u32 s5, s5, s76
s_and_b32 s6, s74, 1
s_mul_i32 s6, s6, 7
s_lshr_b32 s76, s75, 2
s_add_u32 s6, s6, s76
s_lshl_b32 s80, s5, 17
s_lshl_b32 s76, s4, 15
s_add_u32 s80, s80, s76
s_mul_i32 s81, s4, 16*3584
s_lshl_b32 s76, s6, 8
s_add_u32 s81, s81, s76
s_lshl_b32 s82, s4, 12
v_and_b32 v10, 63, v0
v_lshrrev_b32 v11, 3, v10
v_and_b32 v12, 7, v10
v_lshrrev_b32 v13, 4, v10
v_xor_b32 v12, v12, v13
v_lshlrev_b32 v12, 4, v12
v_lshl_add_u32 v1, v11, 10, v12
v_xor_b32 v2, 64, v1
v_and_b32 v12, 15, v10
v_lshlrev_b32 v14, 2, v13
v_xor_b32 v12, v12, v14
v_lshlrev_b32 v12, 4, v12
v_mul_u32_u24 v14, 3584, v13
v_add_u32 v3, v12, v14
v_and_b32 v11, 31, v10
v_lshrrev_b32 v12, 5, v10
v_lshrrev_b32 v13, 1, v11
v_and_b32 v13, 7, v13
v_xor_b32 v13, v13, v12
s_lshr_b32 s76, s4, 1
s_lshl_b32 s76, s76, 13
v_lshlrev_b32 v14, 7, v11
v_add_u32 v14, s76, v14
v_xor_b32 v15, 0, v13
v_lshl_add_u32 v4, v15, 4, v14
v_xor_b32 v15, 2, v13
v_lshl_add_u32 v5, v15, 4, v14
v_xor_b32 v15, 4, v13
v_lshl_add_u32 v6, v15, 4, v14
v_xor_b32 v15, 6, v13
v_lshl_add_u32 v7, v15, 4, v14
v_and_b32 v11, 15, v10
v_lshrrev_b32 v12, 4, v10
v_lshrrev_b32 v13, 2, v11
v_lshrrev_b32 v14, 1, v12
v_lshl_add_u32 v14, v14, 3, v13
v_lshlrev_b32 v14, 8, v14
v_and_b32 v15, 1, v12
v_lshlrev_b32 v15, 1, v15
v_bfe_u32 v16, v11, 1, 1
v_add_u32 v15, v15, v16
s_and_b32 s76, s4, 1
s_lshl_b32 s76, s76, 3
v_add_u32 v15, s76, v15
v_lshlrev_b32 v13, 2, v13
v_xor_b32 v15, v15, v13
v_and_b32 v16, 1, v11
v_lshlrev_b32 v16, 3, v16
v_add_u32 v14, v14, v16
v_lshl_add_u32 v8, v15, 4, v14
v_xor_b32 v9, 64, v8
v_add_u32 v24, 65536, v4
v_add_u32 v25, 65536, v5
v_add_u32 v26, 65536, v6
v_add_u32 v27, 65536, v7
v_add_u32 v28, 65536, v8
v_add_u32 v29, 65536, v9
v_lshlrev_b32 v19, 1, v10
v_cmp_gt_u32 vcc, 32, v10
v_mov_b32 v20, 1073741824
s_nop 0
v_cndmask_b32 v19, v20, v19, vcc
v_mov_b32 v20, 0
v_mov_b32 v21, 0x3f80
v_cndmask_b32 v20, v20, v21, vcc
v_mov_b32 v21, 0
v_mov_b32 v22, 0
v_mov_b32 v23, 0
v_mov_b32 v249, 0
v_mov_b32 v250, 0
v_mov_b32 v251, 0
v_mov_b32 v253, 0
v_mov_b32 v254, 0
v_mov_b32 v255, 0
s_lshl_b32 s76, s6, 8
s_and_b32 s77, s4, 1
s_lshl_b32 s77, s77, 7
s_add_u32 s83, s76, s77
s_lshr_b32 s20, s2, 3
s_add_u32 s20, s5, s6
s_and_b32 s20, s20, 7
s_lshr_b32 s84, s2, 5
s_and_b32 s85, s2, 31
s_lshl_b32 s85, s85, 6
s_and_b32 s74, s4, 1
s_lshr_b32 s75, s4, 1
s_lshl_b32 s76, s74, 5
s_add_u32 s76, s76, s85
s_sub_u32 s77, s76, 3
s_lshl_b32 s77, s77, 10
s_lshl_b32 s78, s84, 7
s_add_u32 s77, s77, s78
s_lshl_b32 s78, s75, 6
s_add_u32 s77, s77, s78
v_and_b32 v15, 15, v0
v_bfe_u32 v16, v0, 4, 2
v_lshlrev_b32 v10, 13, v16
v_lshl_add_u32 v10, v15, 2, v10
v_add_u32 v10, s77, v10
v_add_u32 v11, 1024, v10
v_add_u32 v12, 2048, v10
v_add_u32 v13, 3072, v10
v_add_u32 v14, 7168, v10
v_lshlrev_b32 v17, 4, v15
s_lshl_b32 s78, s84, 9
s_lshl_b32 s79, s75, 8
s_add_u32 s7, s78, s79
v_sub_u32 v16, 3, v16
v_lshlrev_b32 v16, 4, v16
v_lshl_add_u32 v18, v15, 13, v16
s_lshl_b32 s78, s84, 18
s_lshl_b32 s79, s75, 17
s_add_u32 s78, s78, s79
s_sub_u32 s79, 2016, s76
s_lshl_b32 s79, s79, 1
s_add_u32 s78, s78, s79
s_add_u32 s95, s78, 1048576
s_mov_b32 s10, 2097152
s_mov_b32 s11, 0x00020000
s_mov_b32 s26, 1835008
s_mov_b32 s27, 0x00020000
s_mov_b32 s14, 2097152
s_mov_b32 s15, 0x00020000
s_mov_b32 s18, 2097152
s_mov_b32 s19, 0x00020000
s_mov_b32 s30, 1835008
s_mov_b32 s31, 0x00020000
s_mov_b32 s34, 2097152
s_mov_b32 s35, 0x00020000
s_mov_b32 s38, 33554432
s_mov_b32 s39, 0x00020000
s_mov_b32 s43, 0x00020000
s_waitcnt lgkmcnt(0)
s_mov_b32 s8, s44
s_mov_b32 s9, s45
s_mov_b32 s24, s58
s_mov_b32 s25, s59
s_lshl_b32 s56, s20, 7
s_add_u32 s56, s56, s80
s_mul_i32 s57, s20, 229376
s_add_u32 s57, s57, s81
s_add_u32 s20, s20, 1
s_and_b32 s20, s20, 7
s_add_u32 m0, s82, 0
s_add_u32 s22, s56, 0
buffer_load_dwordx4 v1, s[8:11], s22 offen lds
s_add_u32 m0, s82, 1024
s_add_u32 s22, s56, 8192
buffer_load_dwordx4 v2, s[8:11], s22 offen lds
s_add_u32 m0, s82, 2048
s_add_u32 s22, s56, 16384
buffer_load_dwordx4 v1, s[8:11], s22 offen lds
s_add_u32 m0, s82, 3072
s_add_u32 s22, s56, 24576
buffer_load_dwordx4 v2, s[8:11], s22 offen lds
s_add_u32 m0, s82, 16384
s_add_u32 s22, s57, 0
buffer_load_dwordx4 v3, s[24:27], s22 offen lds
s_add_u32 m0, s82, 17408
s_add_u32 s22, s57, 14336
buffer_load_dwordx4 v3, s[24:27], s22 offen lds
s_add_u32 m0, s82, 18432
s_add_u32 s22, s57, 28672
buffer_load_dwordx4 v3, s[24:27], s22 offen lds
s_add_u32 m0, s82, 19456
s_add_u32 s22, s57, 43008
buffer_load_dwordx4 v3, s[24:27], s22 offen lds
s_mov_b32 s12, s46
s_mov_b32 s13, s47
s_mov_b32 s16, s48
s_mov_b32 s17, s49
s_mov_b32 s28, s62
s_mov_b32 s29, s63
s_mov_b32 s32, s68
s_mov_b32 s33, s69
s_mov_b32 s36, s72
s_mov_b32 s37, s73
s_load_dword s96, s[72:73], 98304
s_lshl_b32 s74, s2, 2
s_load_dword s23, s[54:55], s74
s_lshl_b32 s74, s2, 13
s_lshl_b32 s56, s20, 7
s_add_u32 s56, s56, s80
s_mul_i32 s57, s20, 229376
s_add_u32 s57, s57, s81
s_add_u32 s20, s20, 1
s_and_b32 s20, s20, 7
s_add_u32 m0, s82, 32768
s_add_u32 s22, s56, 0
buffer_load_dwordx4 v1, s[8:11], s22 offen lds
s_add_u32 s84, s52, s74
s_addc_u32 s85, s53, 0
s_mov_b32 s86, 4096
s_mov_b32 s87, 0x00020000
s_add_u32 s74, s74, 4096
s_add_u32 s88, s52, s74
s_addc_u32 s89, s53, 0
s_mov_b32 s90, 4096
s_mov_b32 s91, 0x00020000
v_lshlrev_b32 v46, 4, v0
v_add_u32 v47, -16, v46
v_mov_b32 v48, 0
v_mov_b32 v49, 0
s_add_u32 m0, s82, 33792
s_add_u32 s22, s56, 8192
buffer_load_dwordx4 v2, s[8:11], s22 offen lds
v_mov_b32 v50, 0
v_mov_b32 v51, 0
v_add_u32 v52, 143360, v46
v_cmp_gt_u32 vcc, 32, v0
s_and_saveexec_b64 s[74:75], vcc
ds_write_b128 v52, v[48:51] offset:0
ds_write_b128 v52, v[48:51] offset:4608
s_mov_b64 exec, s[74:75]
v_and_b32 v58, 63, v0
s_add_u32 m0, s82, 34816
s_add_u32 s22, s56, 16384
buffer_load_dwordx4 v1, s[8:11], s22 offen lds
s_lshr_b32 s75, s2, 5
s_lshl_b32 s74, s75, 5
v_and_b32 v59, 31, v58
v_add_u32 v61, s74, v59
v_and_b32 v60, 3, v58
v_lshlrev_b32 v60, 3, v60
s_add_u32 s75, s75, 800
v_add_u32 v60, s75, v60
v_cmp_gt_u32 vcc, 32, v58
s_nop 1
v_cndmask_b32 v56, v60, v61, vcc
v_lshlrev_b32 v56, 7, v56
v_add_u32 v61, 256, v61
v_add_u32 v59, 224, v59
s_add_u32 m0, s82, 35840
s_add_u32 s22, s56, 24576
buffer_load_dwordx4 v2, s[8:11], s22 offen lds
v_cndmask_b32 v61, v59, v61, vcc
v_lshlrev_b32 v61, 7, v61
s_and_b32 s74, s2, 7
s_lshl_b32 s74, s74, 2
s_lshr_b32 s75, s2, 3
s_and_b32 s75, s75, 3
s_add_u32 s74, s74, s75
s_lshr_b32 s75, s74, 1
s_lshr_b32 s76, s75, 2
s_lshl_b32 s76, s76, 1
s_and_b32 s77, s75, 3
s_lshl_b32 s77, s77, 3
s_add_u32 s76, s76, s77
s_add_u32 m0, s82, 49152
s_add_u32 s22, s57, 0
buffer_load_dwordx4 v3, s[24:27], s22 offen lds
v_cmp_lt_u32 vcc, 6, v58
s_nop 1
v_cndmask_b32 v59, 0, 1, vcc
v_mul_u32_u24 v60, 7, v59
v_sub_u32 v60, v58, v60
v_lshlrev_b32 v60, 5, v60
v_add_u32 v60, v60, v59
v_cmp_gt_u32 vcc, 14, v58
s_nop 1
v_cndmask_b32 v60, 0, v60, vcc
v_add_u32 v60, s76, v60
v_lshlrev_b32 v57, 7, v60
s_cmp_eq_u32 s4, 0
s_cselect_b32 s74, 0, 1073741824
v_or_b32 v56, s74, v56
s_add_u32 m0, s82, 50176
s_add_u32 s22, s57, 14336
buffer_load_dwordx4 v3, s[24:27], s22 offen lds
v_or_b32 v57, s74, v57
v_or_b32 v61, s74, v61
v_lshlrev_b32 v58, 4, v58
s_waitcnt lgkmcnt(0)
s_mul_i32 s3, s96, 0x9E3779B1
s_add_u32 s3, s3, 0x85EBCA6B
s_lshr_b32 s92, s2, 5
s_lshl_b32 s92, s92, 7
s_mul_i32 s93, s4, 28
s_add_u32 s92, s92, s93
s_lshl_b32 s92, s92, 11
s_add_u32 s92, s92, 3145728
s_and_b32 s93, s4, 1
s_add_u32 m0, s82, 51200
s_add_u32 s22, s57, 28672
buffer_load_dwordx4 v3, s[24:27], s22 offen lds
s_lshl_b32 s93, s93, 10
s_add_u32 s92, s92, s93
s_xor_b32 s93, s92, 1024
s_waitcnt vmcnt(7)
s_barrier
ds_read_b64_tr_b16 v[160:161], v8 offset:16384
ds_read_b64_tr_b16 v[162:163], v8 offset:17408
ds_read_b64_tr_b16 v[164:165], v9 offset:16384
ds_read_b64_tr_b16 v[166:167], v9 offset:17408
ds_read_b128 v[168:171], v4 offset:0
s_add_u32 m0, s82, 52224
s_add_u32 s22, s57, 43008
buffer_load_dwordx4 v3, s[24:27], s22 offen lds
ds_read_b128 v[172:175], v4 offset:4096
ds_read_b64_tr_b16 v[176:177], v8 offset:20480
ds_read_b64_tr_b16 v[178:179], v8 offset:21504
ds_read_b64_tr_b16 v[180:181], v9 offset:20480
ds_read_b64_tr_b16 v[182:183], v9 offset:21504
ds_read_b128 v[184:187], v5 offset:0
ds_read_b128 v[188:191], v5 offset:4096
ds_read_b64_tr_b16 v[192:193], v8 offset:24576
ds_read_b64_tr_b16 v[194:195], v8 offset:25600
ds_read_b64_tr_b16 v[196:197], v9 offset:24576
ds_read_b64_tr_b16 v[198:199], v9 offset:25600
ds_read_b128 v[200:203], v6 offset:0
ds_read_b128 v[204:207], v6 offset:4096
s_mov_b32 s40, s50
s_mov_b32 s41, s51
s_mov_b32 s42, 4096
buffer_load_dwordx4 v[244:247], v17, s[40:43], s7 offen
s_waitcnt lgkmcnt(12)
v_mfma_f32_32x32x16_bf16 v[64:79], v[160:163], v[168:171], 0
buffer_load_dword v224, v10, s[12:15], 0 offen offset:0
buffer_load_dword v225, v11, s[12:15], 0 offen offset:0
buffer_load_dword v226, v12, s[12:15], 0 offen offset:0
buffer_load_dword v227, v13, s[12:15], 0 offen offset:0
buffer_load_dword v228, v13, s[12:15], 0 offen offset:1024
buffer_load_dword v229, v13, s[12:15], 0 offen offset:2048
buffer_load_dword v230, v13, s[12:15], 0 offen offset:3072
buffer_load_dword v231, v14, s[12:15], 0 offen offset:0
buffer_load_dword v232, v14, s[12:15], 0 offen offset:1024
buffer_load_dword v233, v14, s[12:15], 0 offen offset:2048
buffer_load_dword v234, v14, s[12:15], 0 offen offset:3072
buffer_load_dword v235, v13, s[16:19], 0 offen offset:0
buffer_load_dword v236, v13, s[16:19], 0 offen offset:1024
buffer_load_dword v237, v13, s[16:19], 0 offen offset:2048
buffer_load_dword v238, v13, s[16:19], 0 offen offset:3072
buffer_load_dword v239, v14, s[16:19], 0 offen offset:0
buffer_load_dword v240, v14, s[16:19], 0 offen offset:1024
buffer_load_dword v241, v14, s[16:19], 0 offen offset:2048
buffer_load_dword v242, v14, s[16:19], 0 offen offset:3072
s_mov_b32 s40, s60
s_mov_b32 s41, s61
s_mov_b32 s42, 3584
buffer_load_ushort v248, v19, s[40:43], s83 offen
buffer_load_ushort v252, v19, s[40:43], s83 offen offset:64
s_lshl_b32 s56, s20, 7
s_add_u32 s56, s56, s80
s_mul_i32 s57, s20, 229376
s_add_u32 s57, s57, s81
s_add_u32 s20, s20, 1
s_and_b32 s20, s20, 7
s_add_u32 m0, s82, 65536
s_add_u32 s22, s56, 0
buffer_load_dwordx4 v1, s[8:11], s22 offen lds
v_mfma_f32_32x32x16_bf16 v[80:95], v[160:163], v[172:175], 0
v_mfma_f32_32x32x16_bf16 v[96:111], v[164:167], v[168:171], 0
s_add_u32 m0, s82, 66560
s_add_u32 s22, s56, 8192
buffer_load_dwordx4 v2, s[8:11], s22 offen lds
v_mfma_f32_32x32x16_bf16 v[112:127], v[164:167], v[172:175], 0
ds_read_b64_tr_b16 v[208:209], v8 offset:28672
ds_read_b64_tr_b16 v[210:211], v8 offset:29696
ds_read_b64_tr_b16 v[212:213], v9 offset:28672
ds_read_b64_tr_b16 v[214:215], v9 offset:29696
ds_read_b128 v[216:219], v7 offset:0
ds_read_b128 v[220:223], v7 offset:4096
s_waitcnt lgkmcnt(12)
v_mfma_f32_32x32x16_bf16 v[64:79], v[176:179], v[184:187], v[64:79]
s_add_u32 m0, s82, 67584
s_add_u32 s22, s56, 16384
buffer_load_dwordx4 v1, s[8:11], s22 offen lds
v_mfma_f32_32x32x16_bf16 v[80:95], v[176:179], v[188:191], v[80:95]
v_mfma_f32_32x32x16_bf16 v[96:111], v[180:183], v[184:187], v[96:111]
s_add_u32 m0, s82, 68608
s_add_u32 s22, s56, 24576
buffer_load_dwordx4 v2, s[8:11], s22 offen lds
v_mfma_f32_32x32x16_bf16 v[112:127], v[180:183], v[188:191], v[112:127]
s_waitcnt vmcnt(26) lgkmcnt(0)
s_barrier
ds_read_b64_tr_b16 v[160:161], v8 offset:49152
ds_read_b64_tr_b16 v[162:163], v8 offset:50176
ds_read_b64_tr_b16 v[164:165], v9 offset:49152
ds_read_b64_tr_b16 v[166:167], v9 offset:50176
ds_read_b128 v[168:171], v4 offset:32768
ds_read_b128 v[172:175], v4 offset:36864
v_mfma_f32_32x32x16_bf16 v[64:79], v[192:195], v[200:203], v[64:79]
s_add_u32 m0, s82, 81920
s_add_u32 s22, s57, 0
buffer_load_dwordx4 v3, s[24:27], s22 offen lds
v_mfma_f32_32x32x16_bf16 v[80:95], v[192:195], v[204:207], v[80:95]
v_mfma_f32_32x32x16_bf16 v[96:111], v[196:199], v[200:203], v[96:111]
s_add_u32 m0, s82, 82944
s_add_u32 s22, s57, 14336
buffer_load_dwordx4 v3, s[24:27], s22 offen lds
v_mfma_f32_32x32x16_bf16 v[112:127], v[196:199], v[204:207], v[112:127]
ds_read_b64_tr_b16 v[176:177], v8 offset:53248
ds_read_b64_tr_b16 v[178:179], v8 offset:54272
ds_read_b64_tr_b16 v[180:181], v9 offset:53248
ds_read_b64_tr_b16 v[182:183], v9 offset:54272
ds_read_b128 v[184:187], v5 offset:32768
ds_read_b128 v[188:191], v5 offset:36864
v_mfma_f32_32x32x16_bf16 v[64:79], v[208:211], v[216:219], v[64:79]
s_add_u32 m0, s82, 83968
s_add_u32 s22, s57, 28672
buffer_load_dwordx4 v3, s[24:27], s22 offen lds
v_mfma_f32_32x32x16_bf16 v[80:95], v[208:211], v[220:223], v[80:95]
v_mfma_f32_32x32x16_bf16 v[96:111], v[212:215], v[216:219], v[96:111]
s_add_u32 m0, s82, 84992
s_add_u32 s22, s57, 43008
buffer_load_dwordx4 v3, s[24:27], s22 offen lds
v_mfma_f32_32x32x16_bf16 v[112:127], v[212:215], v[220:223], v[112:127]
ds_read_b64_tr_b16 v[192:193], v8 offset:57344
ds_read_b64_tr_b16 v[194:195], v8 offset:58368
ds_read_b64_tr_b16 v[196:197], v9 offset:57344
ds_read_b64_tr_b16 v[198:199], v9 offset:58368
ds_read_b128 v[200:203], v6 offset:32768
ds_read_b128 v[204:207], v6 offset:36864
s_waitcnt lgkmcnt(12)
v_mfma_f32_32x32x16_bf16 v[64:79], v[160:163], v[168:171], v[64:79]
s_lshl_b32 s56, s20, 7
s_add_u32 s56, s56, s80
s_mul_i32 s57, s20, 229376
s_add_u32 s57, s57, s81
s_add_u32 s20, s20, 1
s_and_b32 s20, s20, 7
s_add_u32 m0, s82, 98304
s_add_u32 s22, s56, 0
buffer_load_dwordx4 v1, s[8:11], s22 offen lds
s_waitcnt vmcnt(9)
v_mfma_f32_32x32x16_bf16 v[64:79], v[248:251], v[20:23], v[64:79]
v_mfma_f32_32x32x16_bf16 v[80:95], v[248:251], v[20:23], v[80:95]
s_add_u32 m0, s82, 99328
s_add_u32 s22, s56, 8192
buffer_load_dwordx4 v2, s[8:11], s22 offen lds
v_mfma_f32_32x32x16_bf16 v[96:111], v[252:255], v[20:23], v[96:111]
v_mfma_f32_32x32x16_bf16 v[112:127], v[252:255], v[20:23], v[112:127]
s_add_u32 m0, s82, 100352
s_add_u32 s22, s56, 16384
buffer_load_dwordx4 v1, s[8:11], s22 offen lds
v_mfma_f32_32x32x16_bf16 v[80:95], v[160:163], v[172:175], v[80:95]
v_mfma_f32_32x32x16_bf16 v[96:111], v[164:167], v[168:171], v[96:111]
s_add_u32 m0, s82, 101376
s_add_u32 s22, s56, 24576
buffer_load_dwordx4 v2, s[8:11], s22 offen lds
v_mfma_f32_32x32x16_bf16 v[112:127], v[164:167], v[172:175], v[112:127]
ds_read_b64_tr_b16 v[208:209], v8 offset:61440
ds_read_b64_tr_b16 v[210:211], v8 offset:62464
ds_read_b64_tr_b16 v[212:213], v9 offset:61440
ds_read_b64_tr_b16 v[214:215], v9 offset:62464
ds_read_b128 v[216:219], v7 offset:32768
ds_read_b128 v[220:223], v7 offset:36864
s_waitcnt lgkmcnt(12)
v_mfma_f32_32x32x16_bf16 v[64:79], v[176:179], v[184:187], v[64:79]
s_add_u32 m0, s82, 114688
s_add_u32 s22, s57, 0
buffer_load_dwordx4 v3, s[24:27], s22 offen lds
v_mfma_f32_32x32x16_bf16 v[80:95], v[176:179], v[188:191], v[80:95]
v_mfma_f32_32x32x16_bf16 v[96:111], v[180:183], v[184:187], v[96:111]
s_add_u32 m0, s82, 115712
s_add_u32 s22, s57, 14336
buffer_load_dwordx4 v3, s[24:27], s22 offen lds
v_mfma_f32_32x32x16_bf16 v[112:127], v[180:183], v[188:191], v[112:127]
s_add_u32 m0, s82, 116736
s_add_u32 s22, s57, 28672
buffer_load_dwordx4 v3, s[24:27], s22 offen lds
s_add_u32 m0, s82, 117760
s_add_u32 s22, s57, 43008
buffer_load_dwordx4 v3, s[24:27], s22 offen lds
s_waitcnt vmcnt(8) lgkmcnt(0)
s_barrier
s_lshl_b32 s56, s20, 7
s_add_u32 s56, s56, s80
s_mul_i32 s57, s20, 229376
s_add_u32 s57, s57, s81
s_add_u32 s20, s20, 1
s_and_b32 s20, s20, 7
s_add_u32 m0, s82, 0
s_add_u32 s22, s56, 0
buffer_load_dwordx4 v1, s[8:11], s22 offen lds
ds_read_b64_tr_b16 v[160:161], v28 offset:16384
ds_read_b64_tr_b16 v[162:163], v28 offset:17408
ds_read_b64_tr_b16 v[164:165], v29 offset:16384
ds_read_b64_tr_b16 v[166:167], v29 offset:17408
ds_read_b128 v[168:171], v24 offset:0
ds_read_b128 v[172:175], v24 offset:4096
v_mfma_f32_32x32x16_bf16 v[64:79], v[192:195], v[200:203], v[64:79]
s_add_u32 m0, s82, 1024
s_add_u32 s22, s56, 8192
buffer_load_dwordx4 v2, s[8:11], s22 offen lds
v_lshlrev_b32 v150, 16, v244
v_lshlrev_b32 v151, 16, v246
v_and_b32 v152, 0xffff0000, v244
v_mfma_f32_32x32x16_bf16 v[80:95], v[192:195], v[204:207], v[80:95]
v_and_b32 v153, 0xffff0000, v246
v_lshlrev_b32 v154, 16, v245
v_lshlrev_b32 v155, 16, v247
v_and_b32 v156, 0xffff0000, v245
v_and_b32 v157, 0xffff0000, v247
v_mfma_f32_32x32x16_bf16 v[96:111], v[196:199], v[200:203], v[96:111]
s_add_u32 m0, s82, 2048
s_add_u32 s22, s56, 16384
buffer_load_dwordx4 v1, s[8:11], s22 offen lds
v_lshlrev_b32 v128, 16, v224
v_and_b32 v129, 0xffff0000, v224
v_lshlrev_b32 v130, 16, v225
v_and_b32 v131, 0xffff0000, v225
v_lshlrev_b32 v132, 16, v226
v_mfma_f32_32x32x16_bf16 v[112:127], v[196:199], v[204:207], v[112:127]
s_add_u32 m0, s82, 3072
s_add_u32 s22, s56, 24576
buffer_load_dwordx4 v2, s[8:11], s22 offen lds
v_and_b32 v133, 0xffff0000, v226
v_lshlrev_b32 v134, 16, v227
v_and_b32 v135, 0xffff0000, v227
v_lshlrev_b32 v136, 16, v228
v_and_b32 v137, 0xffff0000, v228
ds_read_b64_tr_b16 v[176:177], v28 offset:20480
ds_read_b64_tr_b16 v[178:179], v28 offset:21504
ds_read_b64_tr_b16 v[180:181], v29 offset:20480
ds_read_b64_tr_b16 v[182:183], v29 offset:21504
ds_read_b128 v[184:187], v25 offset:0
ds_read_b128 v[188:191], v25 offset:4096
v_mfma_f32_32x32x16_bf16 v[64:79], v[208:211], v[216:219], v[64:79]
s_add_u32 m0, s82, 16384
s_add_u32 s22, s57, 0
buffer_load_dwordx4 v3, s[24:27], s22 offen lds
v_lshlrev_b32 v138, 16, v229
v_and_b32 v139, 0xffff0000, v229
v_lshlrev_b32 v140, 16, v230
v_and_b32 v141, 0xffff0000, v230
v_lshlrev_b32 v142, 16, v231
v_mfma_f32_32x32x16_bf16 v[80:95], v[208:211], v[220:223], v[80:95]
s_add_u32 m0, s82, 17408
s_add_u32 s22, s57, 14336
buffer_load_dwordx4 v3, s[24:27], s22 offen lds
v_and_b32 v143, 0xffff0000, v231
v_lshlrev_b32 v144, 16, v232
v_and_b32 v145, 0xffff0000, v232
v_lshlrev_b32 v146, 16, v233
v_and_b32 v147, 0xffff0000, v233
v_mfma_f32_32x32x16_bf16 v[96:111], v[212:215], v[216:219], v[96:111]
s_add_u32 m0, s82, 18432
s_add_u32 s22, s57, 28672
buffer_load_dwordx4 v3, s[24:27], s22 offen lds
v_lshlrev_b32 v148, 16, v234
v_and_b32 v149, 0xffff0000, v234
v_pk_mul_f32 v[30:31], v[134:135], v[150:151]
v_pk_mul_f32 v[32:33], v[136:137], v[150:151]
v_pk_mul_f32 v[34:35], v[138:139], v[150:151]
v_mfma_f32_32x32x16_bf16 v[112:127], v[212:215], v[220:223], v[112:127]
s_add_u32 m0, s82, 19456
s_add_u32 s22, s57, 43008
buffer_load_dwordx4 v3, s[24:27], s22 offen lds
v_pk_mul_f32 v[36:37], v[140:141], v[150:151]
v_pk_mul_f32 v[38:39], v[142:143], v[150:151]
v_pk_mul_f32 v[40:41], v[144:145], v[150:151]
v_pk_mul_f32 v[42:43], v[146:147], v[150:151]
v_pk_mul_f32 v[44:45], v[148:149], v[150:151]
ds_read_b64_tr_b16 v[192:193], v28 offset:24576
ds_read_b64_tr_b16 v[194:195], v28 offset:25600
ds_read_b64_tr_b16 v[196:197], v29 offset:24576
ds_read_b64_tr_b16 v[198:199], v29 offset:25600
ds_read_b128 v[200:203], v26 offset:0
ds_read_b128 v[204:207], v26 offset:4096
s_waitcnt lgkmcnt(12)
v_mfma_f32_32x32x16_bf16 v[64:79], v[160:163], v[168:171], v[64:79]
s_lshl_b32 s56, s20, 7
s_add_u32 s56, s56, s80
s_mul_i32 s57, s20, 229376
s_add_u32 s57, s57, s81
s_add_u32 s20, s20, 1
s_and_b32 s20, s20, 7
s_add_u32 m0, s82, 32768
s_add_u32 s22, s56, 0
buffer_load_dwordx4 v1, s[8:11], s22 offen lds
v_pk_fma_f32 v[30:31], v[132:133], v[152:153], v[30:31]
v_pk_fma_f32 v[32:33], v[134:135], v[152:153], v[32:33]
v_pk_fma_f32 v[34:35], v[136:137], v[152:153], v[34:35]
v_pk_fma_f32 v[36:37], v[138:139], v[152:153], v[36:37]
v_pk_fma_f32 v[38:39], v[140:141], v[152:153], v[38:39]
v_mfma_f32_32x32x16_bf16 v[80:95], v[160:163], v[172:175], v[80:95]
s_add_u32 m0, s82, 33792
s_add_u32 s22, s56, 8192
buffer_load_dwordx4 v2, s[8:11], s22 offen lds
v_pk_fma_f32 v[40:41], v[142:143], v[152:153], v[40:41]
v_pk_fma_f32 v[42:43], v[144:145], v[152:153], v[42:43]
v_pk_fma_f32 v[44:45], v[146:147], v[152:153], v[44:45]
v_pk_fma_f32 v[30:31], v[130:131], v[154:155], v[30:31]
v_pk_fma_f32 v[32:33], v[132:133], v[154:155], v[32:33]
v_mfma_f32_32x32x16_bf16 v[96:111], v[164:167], v[168:171], v[96:111]
s_add_u32 m0, s82, 34816
s_add_u32 s22, s56, 16384
buffer_load_dwordx4 v1, s[8:11], s22 offen lds
v_pk_fma_f32 v[34:35], v[134:135], v[154:155], v[34:35]
v_pk_fma_f32 v[36:37], v[136:137], v[154:155], v[36:37]
v_pk_fma_f32 v[38:39], v[138:139], v[154:155], v[38:39]
v_pk_fma_f32 v[40:41], v[140:141], v[154:155], v[40:41]
v_pk_fma_f32 v[42:43], v[142:143], v[154:155], v[42:43]
v_mfma_f32_32x32x16_bf16 v[112:127], v[164:167], v[172:175], v[112:127]
s_add_u32 m0, s82, 35840
s_add_u32 s22, s56, 24576
buffer_load_dwordx4 v2, s[8:11], s22 offen lds
v_pk_fma_f32 v[44:45], v[144:145], v[154:155], v[44:45]
v_pk_fma_f32 v[30:31], v[128:129], v[156:157], v[30:31]
v_pk_fma_f32 v[32:33], v[130:131], v[156:157], v[32:33]
v_pk_fma_f32 v[34:35], v[132:133], v[156:157], v[34:35]
v_pk_fma_f32 v[36:37], v[134:135], v[156:157], v[36:37]
ds_read_b64_tr_b16 v[208:209], v28 offset:28672
ds_read_b64_tr_b16 v[210:211], v28 offset:29696
ds_read_b64_tr_b16 v[212:213], v29 offset:28672
ds_read_b64_tr_b16 v[214:215], v29 offset:29696
ds_read_b128 v[216:219], v27 offset:0
ds_read_b128 v[220:223], v27 offset:4096
s_waitcnt lgkmcnt(12)
v_mfma_f32_32x32x16_bf16 v[64:79], v[176:179], v[184:187], v[64:79]
s_add_u32 m0, s82, 49152
s_add_u32 s22, s57, 0
buffer_load_dwordx4 v3, s[24:27], s22 offen lds
v_pk_fma_f32 v[38:39], v[136:137], v[156:157], v[38:39]
v_pk_fma_f32 v[40:41], v[138:139], v[156:157], v[40:41]
v_pk_fma_f32 v[42:43], v[140:141], v[156:157], v[42:43]
v_pk_fma_f32 v[44:45], v[142:143], v[156:157], v[44:45]
v_lshlrev_b32 v128, 16, v235
v_mfma_f32_32x32x16_bf16 v[80:95], v[176:179], v[188:191], v[80:95]
s_add_u32 m0, s82, 50176
s_add_u32 s22, s57, 14336
buffer_load_dwordx4 v3, s[24:27], s22 offen lds
v_and_b32 v129, 0xffff0000, v235
v_lshlrev_b32 v130, 16, v236
v_and_b32 v131, 0xffff0000, v236
v_lshlrev_b32 v132, 16, v237
v_and_b32 v133, 0xffff0000, v237
v_mfma_f32_32x32x16_bf16 v[96:111], v[180:183], v[184:187], v[96:111]
s_add_u32 m0, s82, 51200
s_add_u32 s22, s57, 28672
buffer_load_dwordx4 v3, s[24:27], s22 offen lds
v_lshlrev_b32 v134, 16, v238
v_and_b32 v135, 0xffff0000, v238
v_lshlrev_b32 v136, 16, v239
v_and_b32 v137, 0xffff0000, v239
v_lshlrev_b32 v138, 16, v240
v_mfma_f32_32x32x16_bf16 v[112:127], v[180:183], v[188:191], v[112:127]
s_add_u32 m0, s82, 52224
s_add_u32 s22, s57, 43008
buffer_load_dwordx4 v3, s[24:27], s22 offen lds
v_and_b32 v139, 0xffff0000, v240
v_lshlrev_b32 v140, 16, v241
v_and_b32 v141, 0xffff0000, v241
v_lshlrev_b32 v142, 16, v242
v_and_b32 v143, 0xffff0000, v242
s_waitcnt vmcnt(16) lgkmcnt(0)
s_barrier
ds_read_b64_tr_b16 v[160:161], v28 offset:49152
ds_read_b64_tr_b16 v[162:163], v28 offset:50176
ds_read_b64_tr_b16 v[164:165], v29 offset:49152
s_lshl_b32 s56, s20, 7
s_add_u32 s56, s56, s80
s_mul_i32 s57, s20, 229376
s_add_u32 s57, s57, s81
s_add_u32 s20, s20, 1
s_and_b32 s20, s20, 7
s_add_u32 m0, s82, 65536
s_add_u32 s22, s56, 0
buffer_load_dwordx4 v1, s[8:11], s22 offen lds
ds_read_b64_tr_b16 v[166:167], v29 offset:50176
ds_read_b128 v[168:171], v24 offset:32768
ds_read_b128 v[172:175], v24 offset:36864
v_mfma_f32_32x32x16_bf16 v[64:79], v[192:195], v[200:203], v[64:79]
v_pk_mul_f32 v[30:31], v[30:31], v[128:129]
v_pk_mul_f32 v[32:33], v[32:33], v[130:131]
v_pk_mul_f32 v[34:35], v[34:35], v[132:133]
v_pk_mul_f32 v[36:37], v[36:37], v[134:135]
v_pk_mul_f32 v[38:39], v[38:39], v[136:137]
v_mfma_f32_32x32x16_bf16 v[80:95], v[192:195], v[204:207], v[80:95]
s_add_u32 m0, s82, 66560
s_add_u32 s22, s56, 8192
buffer_load_dwordx4 v2, s[8:11], s22 offen lds
v_pk_mul_f32 v[40:41], v[40:41], v[138:139]
v_pk_mul_f32 v[42:43], v[42:43], v[140:141]
v_pk_mul_f32 v[44:45], v[44:45], v[142:143]
v_cvt_pk_bf16_f32 v144, v44, v42
v_cvt_pk_bf16_f32 v145, v40, v38
v_mfma_f32_32x32x16_bf16 v[96:111], v[196:199], v[200:203], v[96:111]
s_add_u32 m0, s82, 67584
s_add_u32 s22, s56, 16384
buffer_load_dwordx4 v1, s[8:11], s22 offen lds
v_cvt_pk_bf16_f32 v146, v36, v34
v_cvt_pk_bf16_f32 v147, v32, v30
buffer_store_dwordx4 v[144:147], v18, s[36:39], s95 offen sc1
v_cvt_pk_bf16_f32 v148, v45, v43
v_cvt_pk_bf16_f32 v149, v41, v39
v_mfma_f32_32x32x16_bf16 v[112:127], v[196:199], v[204:207], v[112:127]
v_cvt_pk_bf16_f32 v150, v37, v35
v_cvt_pk_bf16_f32 v151, v33, v31
s_add_u32 s95, s95, 4096
buffer_store_dwordx4 v[148:151], v18, s[36:39], s95 offen sc1
ds_read_b64_tr_b16 v[176:177], v28 offset:53248
ds_read_b64_tr_b16 v[178:179], v28 offset:54272
ds_read_b64_tr_b16 v[180:181], v29 offset:53248
ds_read_b64_tr_b16 v[182:183], v29 offset:54272
ds_read_b128 v[184:187], v25 offset:32768
ds_read_b128 v[188:191], v25 offset:36864
v_mfma_f32_32x32x16_bf16 v[64:79], v[208:211], v[216:219], v[64:79]
v_mfma_f32_32x32x16_bf16 v[80:95], v[208:211], v[220:223], v[80:95]
v_mfma_f32_32x32x16_bf16 v[96:111], v[212:215], v[216:219], v[96:111]
v_mfma_f32_32x32x16_bf16 v[112:127], v[212:215], v[220:223], v[112:127]
ds_read_b64_tr_b16 v[192:193], v28 offset:57344
ds_read_b64_tr_b16 v[194:195], v28 offset:58368
ds_read_b64_tr_b16 v[196:197], v29 offset:57344
ds_read_b64_tr_b16 v[198:199], v29 offset:58368
ds_read_b128 v[200:203], v26 offset:32768
ds_read_b128 v[204:207], v26 offset:36864
s_waitcnt lgkmcnt(12)
v_mfma_f32_32x32x16_bf16 v[64:79], v[160:163], v[168:171], v[64:79]
v_mfma_f32_32x32x16_bf16 v[80:95], v[160:163], v[172:175], v[80:95]
v_mfma_f32_32x32x16_bf16 v[96:111], v[164:167], v[168:171], v[96:111]
v_mfma_f32_32x32x16_bf16 v[112:127], v[164:167], v[172:175], v[112:127]
s_add_u32 m0, s82, 68608
s_add_u32 s22, s56, 24576
buffer_load_dwordx4 v2, s[8:11], s22 offen lds
ds_read_b64_tr_b16 v[208:209], v28 offset:61440
ds_read_b64_tr_b16 v[210:211], v28 offset:62464
ds_read_b64_tr_b16 v[212:213], v29 offset:61440
ds_read_b64_tr_b16 v[214:215], v29 offset:62464
ds_read_b128 v[216:219], v27 offset:32768
ds_read_b128 v[220:223], v27 offset:36864
s_waitcnt lgkmcnt(12)
v_mfma_f32_32x32x16_bf16 v[64:79], v[176:179], v[184:187], v[64:79]
s_add_u32 m0, s82, 81920
s_add_u32 s22, s57, 0
buffer_load_dwordx4 v3, s[24:27], s22 offen lds
v_mfma_f32_32x32x16_bf16 v[80:95], v[176:179], v[188:191], v[80:95]
v_mfma_f32_32x32x16_bf16 v[96:111], v[180:183], v[184:187], v[96:111]
s_add_u32 m0, s82, 82944
s_add_u32 s22, s57, 14336
buffer_load_dwordx4 v3, s[24:27], s22 offen lds
v_mfma_f32_32x32x16_bf16 v[112:127], v[180:183], v[188:191], v[112:127]
s_waitcnt vmcnt(16) lgkmcnt(0)
s_barrier
s_mov_b32 s94, 0
buffer_load_dword v62, v56, s[36:39], s94 offen sc1
ds_read_b64_tr_b16 v[160:161], v8 offset:16384
s_add_u32 m0, s82, 83968
s_add_u32 s22, s57, 28672
buffer_load_dwordx4 v3, s[24:27], s22 offen lds
ds_read_b64_tr_b16 v[162:163], v8 offset:17408
ds_read_b64_tr_b16 v[164:165], v9 offset:16384
ds_read_b64_tr_b16 v[166:167], v9 offset:17408
ds_read_b128 v[168:171], v4 offset:0
ds_read_b128 v[172:175], v4 offset:4096
v_mfma_f32_32x32x16_bf16 v[64:79], v[192:195], v[200:203], v[64:79]
s_add_u32 m0, s82, 84992
s_add_u32 s22, s57, 43008
buffer_load_dwordx4 v3, s[24:27], s22 offen lds
v_mfma_f32_32x32x16_bf16 v[80:95], v[192:195], v[204:207], v[80:95]
v_mfma_f32_32x32x16_bf16 v[96:111], v[196:199], v[200:203], v[96:111]
s_lshl_b32 s56, s20, 7
s_add_u32 s56, s56, s80
s_mul_i32 s57, s20, 229376
s_add_u32 s57, s57, s81
s_add_u32 s20, s20, 1
s_and_b32 s20, s20, 7
s_add_u32 m0, s82, 98304
s_add_u32 s22, s56, 0
buffer_load_dwordx4 v1, s[8:11], s22 offen lds
v_mfma_f32_32x32x16_bf16 v[112:127], v[196:199], v[204:207], v[112:127]
ds_read_b64_tr_b16 v[176:177], v8 offset:20480
ds_read_b64_tr_b16 v[178:179], v8 offset:21504
ds_read_b64_tr_b16 v[180:181], v9 offset:20480
ds_read_b64_tr_b16 v[182:183], v9 offset:21504
ds_read_b128 v[184:187], v5 offset:0
ds_read_b128 v[188:191], v5 offset:4096
v_mfma_f32_32x32x16_bf16 v[64:79], v[208:211], v[216:219], v[64:79]
s_add_u32 m0, s82, 99328
s_add_u32 s22, s56, 8192
buffer_load_dwordx4 v2, s[8:11], s22 offen lds
v_mfma_f32_32x32x16_bf16 v[80:95], v[208:211], v[220:223], v[80:95]
v_mfma_f32_32x32x16_bf16 v[96:111], v[212:215], v[216:219], v[96:111]
s_add_u32 m0, s82, 100352
s_add_u32 s22, s56, 16384
buffer_load_dwordx4 v1, s[8:11], s22 offen lds
v_mfma_f32_32x32x16_bf16 v[112:127], v[212:215], v[220:223], v[112:127]
ds_read_b64_tr_b16 v[192:193], v8 offset:24576
ds_read_b64_tr_b16 v[194:195], v8 offset:25600
ds_read_b64_tr_b16 v[196:197], v9 offset:24576
ds_read_b64_tr_b16 v[198:199], v9 offset:25600
ds_read_b128 v[200:203], v6 offset:0
ds_read_b128 v[204:207], v6 offset:4096
s_waitcnt lgkmcnt(12)
v_mfma_f32_32x32x16_bf16 v[64:79], v[160:163], v[168:171], v[64:79]
s_add_u32 m0, s82, 101376
s_add_u32 s22, s56, 24576
buffer_load_dwordx4 v2, s[8:11], s22 offen lds
v_mfma_f32_32x32x16_bf16 v[80:95], v[160:163], v[172:175], v[80:95]
v_mfma_f32_32x32x16_bf16 v[96:111], v[164:167], v[168:171], v[96:111]
s_add_u32 m0, s82, 114688
s_add_u32 s22, s57, 0
buffer_load_dwordx4 v3, s[24:27], s22 offen lds
v_mfma_f32_32x32x16_bf16 v[112:127], v[164:167], v[172:175], v[112:127]
ds_read_b64_tr_b16 v[208:209], v8 offset:28672
ds_read_b64_tr_b16 v[210:211], v8 offset:29696
ds_read_b64_tr_b16 v[212:213], v9 offset:28672
ds_read_b64_tr_b16 v[214:215], v9 offset:29696
ds_read_b128 v[216:219], v7 offset:0
ds_read_b128 v[220:223], v7 offset:4096
s_waitcnt lgkmcnt(12)
v_mfma_f32_32x32x16_bf16 v[64:79], v[176:179], v[184:187], v[64:79]
s_add_u32 m0, s82, 115712
s_add_u32 s22, s57, 14336
buffer_load_dwordx4 v3, s[24:27], s22 offen lds
v_mfma_f32_32x32x16_bf16 v[80:95], v[176:179], v[188:191], v[80:95]
v_mfma_f32_32x32x16_bf16 v[96:111], v[180:183], v[184:187], v[96:111]
s_add_u32 m0, s82, 116736
s_add_u32 s22, s57, 28672
buffer_load_dwordx4 v3, s[24:27], s22 offen lds
v_mfma_f32_32x32x16_bf16 v[112:127], v[180:183], v[188:191], v[112:127]
s_waitcnt vmcnt(13)
s_waitcnt vmcnt(9)
s_cmp_eq_u32 s4, 0
s_cbranch_scc0 POK_1
v_cmp_ne_u32 vcc, s3, v62
s_cmp_eq_u32 vcc_hi, 0
s_cbranch_scc1 POK_1
s_mov_b32 s97, 0
s_mov_b32 s101, 32768
PRT_2:
s_sleep 1
buffer_load_dword v62, v56, s[36:39], s97 offen sc1
s_waitcnt vmcnt(0)
v_cmp_ne_u32 vcc, s3, v62
s_cmp_eq_u32 vcc_hi, 0
s_cbranch_scc1 POK_1
s_sub_u32 s101, s101, 1
s_cbranch_scc0 PRT_2
POK_1:
s_add_u32 m0, s82, 117760
s_add_u32 s22, s57, 43008
buffer_load_dwordx4 v3, s[24:27], s22 offen lds
s_waitcnt lgkmcnt(0)
s_barrier
s_cmp_eq_u32 s4, 0
s_cbranch_scc0 PUB_3
s_lshl_b32 s97, s2, 7
s_add_u32 s97, s97, 0
v_mov_b32 v62, s3
s_mov_b64 exec, 1
buffer_store_dword v62, off, s[36:39], s97 sc1
s_mov_b64 exec, -1
PUB_3:
buffer_load_dwordx4 v[30:33], v47, s[84:87], 0 offen
ds_read_b64_tr_b16 v[160:161], v8 offset:49152
ds_read_b64_tr_b16 v[162:163], v8 offset:50176
ds_read_b64_tr_b16 v[164:165], v9 offset:49152
ds_read_b64_tr_b16 v[166:167], v9 offset:50176
ds_read_b128 v[168:171], v4 offset:32768
ds_read_b128 v[172:175], v4 offset:36864
v_mfma_f32_32x32x16_bf16 v[64:79], v[192:195], v[200:203], v[64:79]
v_mfma_f32_32x32x16_bf16 v[80:95], v[192:195], v[204:207], v[80:95]
buffer_load_dwordx4 v[34:37], v46, s[84:87], 0 offen
v_mfma_f32_32x32x16_bf16 v[96:111], v[196:199], v[200:203], v[96:111]
v_mfma_f32_32x32x16_bf16 v[112:127], v[196:199], v[204:207], v[112:127]
ds_read_b64_tr_b16 v[176:177], v8 offset:53248
ds_read_b64_tr_b16 v[178:179], v8 offset:54272
ds_read_b64_tr_b16 v[180:181], v9 offset:53248
ds_read_b64_tr_b16 v[182:183], v9 offset:54272
ds_read_b128 v[184:187], v5 offset:32768
ds_read_b128 v[188:191], v5 offset:36864
v_mfma_f32_32x32x16_bf16 v[64:79], v[208:211], v[216:219], v[64:79]
buffer_load_dwordx4 v[38:41], v47, s[88:91], 0 offen
v_mfma_f32_32x32x16_bf16 v[80:95], v[208:211], v[220:223], v[80:95]
v_mfma_f32_32x32x16_bf16 v[96:111], v[212:215], v[216:219], v[96:111]
v_mfma_f32_32x32x16_bf16 v[112:127], v[212:215], v[220:223], v[112:127]
buffer_load_dwordx4 v[42:45], v46, s[88:91], 0 offen
ds_read_b64_tr_b16 v[192:193], v8 offset:57344
ds_read_b64_tr_b16 v[194:195], v8 offset:58368
ds_read_b64_tr_b16 v[196:197], v9 offset:57344
ds_read_b64_tr_b16 v[198:199], v9 offset:58368
ds_read_b128 v[200:203], v6 offset:32768
ds_read_b128 v[204:207], v6 offset:36864
s_waitcnt lgkmcnt(12)
v_mfma_f32_32x32x16_bf16 v[64:79], v[160:163], v[168:171], v[64:79]
v_mfma_f32_32x32x16_bf16 v[80:95], v[160:163], v[172:175], v[80:95]
buffer_load_dwordx4 a[0:3], v58, s[36:39], s92 offen offset:0 sc1
v_mfma_f32_32x32x16_bf16 v[96:111], v[164:167], v[168:171], v[96:111]
v_mfma_f32_32x32x16_bf16 v[112:127], v[164:167], v[172:175], v[112:127]
ds_read_b64_tr_b16 v[208:209], v8 offset:61440
ds_read_b64_tr_b16 v[210:211], v8 offset:62464
ds_read_b64_tr_b16 v[212:213], v9 offset:61440
ds_read_b64_tr_b16 v[214:215], v9 offset:62464
ds_read_b128 v[216:219], v7 offset:32768
ds_read_b128 v[220:223], v7 offset:36864
s_waitcnt lgkmcnt(12)
v_mfma_f32_32x32x16_bf16 v[64:79], v[176:179], v[184:187], v[64:79]
buffer_load_dwordx4 a[4:7], v58, s[36:39], s93 offen offset:0 sc1
v_mfma_f32_32x32x16_bf16 v[80:95], v[176:179], v[188:191], v[80:95]
v_mfma_f32_32x32x16_bf16 v[96:111], v[180:183], v[184:187], v[96:111]
v_mfma_f32_32x32x16_bf16 v[112:127], v[180:183], v[188:191], v[112:127]
buffer_load_dwordx4 a[8:11], v58, s[36:39], s92 offen offset:2048 sc1
s_waitcnt vmcnt(15) lgkmcnt(0)
s_barrier
s_mov_b32 s94, 0
buffer_load_dword v62, v56, s[36:39], s94 offen sc1
ds_read_b64_tr_b16 v[160:161], v28 offset:16384
ds_read_b64_tr_b16 v[162:163], v28 offset:17408
ds_read_b64_tr_b16 v[164:165], v29 offset:16384
ds_read_b64_tr_b16 v[166:167], v29 offset:17408
ds_read_b128 v[168:171], v24 offset:0
ds_read_b128 v[172:175], v24 offset:4096
v_mfma_f32_32x32x16_bf16 v[64:79], v[192:195], v[200:203], v[64:79]
buffer_load_dwordx4 a[12:15], v58, s[36:39], s93 offen offset:2048 sc1
v_mfma_f32_32x32x16_bf16 v[80:95], v[192:195], v[204:207], v[80:95]
v_mfma_f32_32x32x16_bf16 v[96:111], v[196:199], v[200:203], v[96:111]
v_mfma_f32_32x32x16_bf16 v[112:127], v[196:199], v[204:207], v[112:127]
s_add_u32 s92, s92, 4096
buffer_load_dwordx4 a[16:19], v58, s[36:39], s92 offen offset:0 sc1
ds_read_b64_tr_b16 v[176:177], v28 offset:20480
ds_read_b64_tr_b16 v[178:179], v28 offset:21504
ds_read_b64_tr_b16 v[180:181], v29 offset:20480
ds_read_b64_tr_b16 v[182:183], v29 offset:21504
ds_read_b128 v[184:187], v25 offset:0
ds_read_b128 v[188:191], v25 offset:4096
v_mfma_f32_32x32x16_bf16 v[64:79], v[208:211], v[216:219], v[64:79]
v_mfma_f32_32x32x16_bf16 v[80:95], v[208:211], v[220:223], v[80:95]
s_add_u32 s93, s93, 4096
buffer_load_dwordx4 a[20:23], v58, s[36:39], s93 offen offset:0 sc1
v_mfma_f32_32x32x16_bf16 v[96:111], v[212:215], v[216:219], v[96:111]
v_mfma_f32_32x32x16_bf16 v[112:127], v[212:215], v[220:223], v[112:127]
ds_read_b64_tr_b16 v[192:193], v28 offset:24576
ds_read_b64_tr_b16 v[194:195], v28 offset:25600
ds_read_b64_tr_b16 v[196:197], v29 offset:24576
ds_read_b64_tr_b16 v[198:199], v29 offset:25600
ds_read_b128 v[200:203], v26 offset:0
ds_read_b128 v[204:207], v26 offset:4096
s_waitcnt lgkmcnt(12)
v_mfma_f32_32x32x16_bf16 v[64:79], v[160:163], v[168:171], v[64:79]
buffer_load_dwordx4 a[24:27], v58, s[36:39], s92 offen offset:2048 sc1
v_mfma_f32_32x32x16_bf16 v[80:95], v[160:163], v[172:175], v[80:95]
v_mfma_f32_32x32x16_bf16 v[96:111], v[164:167], v[168:171], v[96:111]
v_mfma_f32_32x32x16_bf16 v[112:127], v[164:167], v[172:175], v[112:127]
buffer_load_dwordx4 a[28:31], v58, s[36:39], s93 offen offset:2048 sc1
ds_read_b64_tr_b16 v[208:209], v28 offset:28672
ds_read_b64_tr_b16 v[210:211], v28 offset:29696
ds_read_b64_tr_b16 v[212:213], v29 offset:28672
ds_read_b64_tr_b16 v[214:215], v29 offset:29696
ds_read_b128 v[216:219], v27 offset:0
ds_read_b128 v[220:223], v27 offset:4096
s_waitcnt lgkmcnt(12)
v_mfma_f32_32x32x16_bf16 v[64:79], v[176:179], v[184:187], v[64:79]
v_mfma_f32_32x32x16_bf16 v[80:95], v[176:179], v[188:191], v[80:95]
s_add_u32 s92, s92, 4096
buffer_load_dwordx4 a[32:35], v58, s[36:39], s92 offen offset:0 sc1
v_mfma_f32_32x32x16_bf16 v[96:111], v[180:183], v[184:187], v[96:111]
v_mfma_f32_32x32x16_bf16 v[112:127], v[180:183], v[188:191], v[112:127]
s_add_u32 s93, s93, 4096
buffer_load_dwordx4 a[36:39], v58, s[36:39], s93 offen offset:0 sc1
buffer_load_dwordx4 a[40:43], v58, s[36:39], s92 offen offset:2048 sc1
s_waitcnt vmcnt(8)
s_cmp_eq_u32 s4, 0
s_cbranch_scc0 POK_4
v_cmp_ne_u32 vcc, s3, v62
s_cmp_eq_u32 vcc_lo, 0
s_cbranch_scc1 POK_4
s_mov_b32 s97, 0
s_mov_b32 s101, 32768
PRT_5:
s_sleep 1
buffer_load_dword v62, v56, s[36:39], s97 offen sc1
s_waitcnt vmcnt(0)
v_cmp_ne_u32 vcc, s3, v62
s_cmp_eq_u32 vcc_lo, 0
s_cbranch_scc1 POK_4
s_sub_u32 s101, s101, 1
s_cbranch_scc0 PRT_5
POK_4:
buffer_load_dwordx4 a[44:47], v58, s[36:39], s93 offen offset:2048 sc1
s_waitcnt lgkmcnt(0)
s_barrier
s_lshl_b32 s94, s2, 13
s_add_u32 s94, s94, 1048576
buffer_load_dwordx4 v[244:247], v46, s[36:39], s94 offen sc1
s_lshl_b32 s94, s2, 13
s_add_u32 s94, s94, 1052672
buffer_load_dwordx4 v[248:251], v46, s[36:39], s94 offen sc1
ds_read_b64_tr_b16 v[160:161], v28 offset:49152
ds_read_b64_tr_b16 v[162:163], v28 offset:50176
ds_read_b64_tr_b16 v[164:165], v29 offset:49152
ds_read_b64_tr_b16 v[166:167], v29 offset:50176
ds_read_b128 v[168:171], v24 offset:32768
ds_read_b128 v[172:175], v24 offset:36864
v_mfma_f32_32x32x16_bf16 v[64:79], v[192:195], v[200:203], v[64:79]
v_add_u32 v52, 16, v46
v_mfma_f32_32x32x16_bf16 v[80:95], v[192:195], v[204:207], v[80:95]
s_add_u32 s92, s92, 4096
buffer_load_dwordx4 a[48:51], v58, s[36:39], s92 offen offset:0 sc1
v_add_u32 v53, 35088, v46
ds_write_b128 v52, v[30:33] offset:0
v_mfma_f32_32x32x16_bf16 v[96:111], v[196:199], v[200:203], v[96:111]
ds_write_b128 v52, v[32:35] offset:17536
v_mov_b32 v128, v31
v_mfma_f32_32x32x16_bf16 v[112:127], v[196:199], v[204:207], v[112:127]
v_mov_b32 v129, v32
v_mov_b32 v130, v33
ds_read_b64_tr_b16 v[176:177], v28 offset:53248
ds_read_b64_tr_b16 v[178:179], v28 offset:54272
ds_read_b64_tr_b16 v[180:181], v29 offset:53248
ds_read_b64_tr_b16 v[182:183], v29 offset:54272
ds_read_b128 v[184:187], v25 offset:32768
ds_read_b128 v[188:191], v25 offset:36864
s_add_u32 s93, s93, 4096
buffer_load_dwordx4 a[52:55], v58, s[36:39], s93 offen offset:0 sc1
v_mfma_f32_32x32x16_bf16 v[64:79], v[208:211], v[216:219], v[64:79]
v_mov_b32 v131, v34
v_mov_b32 v132, v35
v_mfma_f32_32x32x16_bf16 v[80:95], v[208:211], v[220:223], v[80:95]
v_mov_b32 v133, v36
ds_write_b128 v52, v[128:131] offset:8768
v_mfma_f32_32x32x16_bf16 v[96:111], v[212:215], v[216:219], v[96:111]
buffer_load_dwordx4 a[56:59], v58, s[36:39], s92 offen offset:2048 sc1
ds_write_b128 v52, v[130:133] offset:26288
v_alignbyte_b32 v134, v31, v30, 2
v_mfma_f32_32x32x16_bf16 v[112:127], v[212:215], v[220:223], v[112:127]
v_alignbyte_b32 v135, v32, v31, 2
v_alignbyte_b32 v136, v33, v32, 2
ds_read_b64_tr_b16 v[192:193], v28 offset:57344
ds_read_b64_tr_b16 v[194:195], v28 offset:58368
ds_read_b64_tr_b16 v[196:197], v29 offset:57344
ds_read_b64_tr_b16 v[198:199], v29 offset:58368
ds_read_b128 v[200:203], v26 offset:32768
ds_read_b128 v[204:207], v26 offset:36864
s_waitcnt lgkmcnt(15)
v_mfma_f32_32x32x16_bf16 v[64:79], v[160:163], v[168:171], v[64:79]
buffer_load_dwordx4 a[60:63], v58, s[36:39], s93 offen offset:2048 sc1
v_alignbyte_b32 v137, v34, v33, 2
v_alignbyte_b32 v138, v35, v34, 2
v_mfma_f32_32x32x16_bf16 v[80:95], v[160:163], v[172:175], v[80:95]
v_alignbyte_b32 v139, v36, v35, 2
ds_write_b128 v52, v[134:137] offset:4368
v_mfma_f32_32x32x16_bf16 v[96:111], v[164:167], v[168:171], v[96:111]
ds_write_b128 v52, v[136:139] offset:21888
v_alignbyte_b32 v140, v32, v31, 2
v_mfma_f32_32x32x16_bf16 v[112:127], v[164:167], v[172:175], v[112:127]
s_add_u32 s92, s92, 4096
buffer_load_dwordx4 a[64:67], v58, s[36:39], s92 offen offset:0 sc1
v_alignbyte_b32 v141, v33, v32, 2
v_alignbyte_b32 v142, v34, v33, 2
ds_read_b64_tr_b16 v[208:209], v28 offset:61440
ds_read_b64_tr_b16 v[210:211], v28 offset:62464
ds_read_b64_tr_b16 v[212:213], v29 offset:61440
ds_read_b64_tr_b16 v[214:215], v29 offset:62464
ds_read_b128 v[216:219], v27 offset:32768
ds_read_b128 v[220:223], v27 offset:36864
s_waitcnt lgkmcnt(15)
v_mfma_f32_32x32x16_bf16 v[64:79], v[176:179], v[184:187], v[64:79]
v_alignbyte_b32 v143, v35, v34, 2
v_alignbyte_b32 v144, v36, v35, 2
v_mfma_f32_32x32x16_bf16 v[80:95], v[176:179], v[188:191], v[80:95]
s_add_u32 s93, s93, 4096
buffer_load_dwordx4 a[68:71], v58, s[36:39], s93 offen offset:0 sc1
v_alignbyte_b32 v145, v37, v36, 2
ds_write_b128 v52, v[140:143] offset:13136
v_mfma_f32_32x32x16_bf16 v[96:111], v[180:183], v[184:187], v[96:111]
ds_write_b128 v52, v[142:145] offset:30656
ds_write_b128 v53, v[38:41] offset:0
v_mfma_f32_32x32x16_bf16 v[112:127], v[180:183], v[188:191], v[112:127]
ds_write_b128 v53, v[40:43] offset:17536
v_mov_b32 v224, v39
s_waitcnt lgkmcnt(12)
v_mfma_f32_32x32x16_bf16 v[64:79], v[192:195], v[200:203], v[64:79]
buffer_load_dwordx4 a[72:75], v58, s[36:39], s92 offen offset:2048 sc1
v_mov_b32 v225, v40
v_mov_b32 v226, v41
v_mfma_f32_32x32x16_bf16 v[80:95], v[192:195], v[204:207], v[80:95]
v_mov_b32 v227, v42
v_mov_b32 v228, v43
v_mfma_f32_32x32x16_bf16 v[96:111], v[196:199], v[200:203], v[96:111]
buffer_load_dwordx4 a[76:79], v58, s[36:39], s93 offen offset:2048 sc1
v_mov_b32 v229, v44
ds_write_b128 v53, v[224:227] offset:8768
v_mfma_f32_32x32x16_bf16 v[112:127], v[196:199], v[204:207], v[112:127]
ds_write_b128 v53, v[226:229] offset:26288
v_alignbyte_b32 v230, v39, v38, 2
s_waitcnt lgkmcnt(6)
v_mfma_f32_32x32x16_bf16 v[64:79], v[208:211], v[216:219], v[64:79]
v_alignbyte_b32 v231, v40, v39, 2
v_alignbyte_b32 v232, v41, v40, 2
v_mfma_f32_32x32x16_bf16 v[80:95], v[208:211], v[220:223], v[80:95]
s_add_u32 s92, s92, 4096
buffer_load_dwordx4 a[80:83], v58, s[36:39], s92 offen offset:0 sc1
v_alignbyte_b32 v233, v42, v41, 2
v_alignbyte_b32 v234, v43, v42, 2
v_mfma_f32_32x32x16_bf16 v[96:111], v[212:215], v[216:219], v[96:111]
v_alignbyte_b32 v235, v44, v43, 2
ds_write_b128 v53, v[230:233] offset:4368
v_mfma_f32_32x32x16_bf16 v[112:127], v[212:215], v[220:223], v[112:127]
s_add_u32 s93, s93, 4096
buffer_load_dwordx4 a[84:87], v58, s[36:39], s93 offen offset:0 sc1
ds_write_b128 v53, v[232:235] offset:21888
v_alignbyte_b32 v236, v40, v39, 2
v_alignbyte_b32 v237, v41, v40, 2
v_alignbyte_b32 v238, v42, v41, 2
v_alignbyte_b32 v239, v43, v42, 2
v_alignbyte_b32 v240, v44, v43, 2
v_alignbyte_b32 v241, v45, v44, 2
ds_write_b128 v53, v[236:239] offset:13136
ds_write_b128 v53, v[238:241] offset:30656
s_mov_b32 s76, 255
v_cmp_eq_u32 vcc, s76, v0
s_and_saveexec_b64 s[74:75], vcc
ds_write_b128 v52, v[34:37] offset:16
ds_write_b128 v53, v[42:45] offset:16
s_mov_b64 exec, s[74:75]
buffer_load_dwordx4 a[88:91], v58, s[36:39], s92 offen offset:2048 sc1
s_mov_b32 s76, 3414709264
v_lshlrev_b32 v54, 2, v0
v_bfe_u32 v54, s76, v54, 4
v_lshlrev_b32 v54, 4, v54
v_mul_u32_u24 v55, 4352, v0
v_add_u32 v54, v54, v55
v_add_u32 v54, 0, v54
v_cmp_gt_u32 vcc, 8, v0
s_and_saveexec_b64 s[74:75], vcc
ds_write_b128 v54, v[48:51]
ds_write_b128 v54, v[48:51] offset:35072
s_mov_b64 exec, s[74:75]
v_and_b32 v10, 63, v0
v_and_b32 v11, 15, v10
v_lshrrev_b32 v12, 4, v10
v_add_u32 v13, 1, v11
v_and_b32 v14, 7, v13
buffer_load_dwordx4 a[92:95], v58, s[36:39], s93 offen offset:2048 sc1
v_lshrrev_b32 v15, 3, v13
s_mov_b32 s74, 3414709264
v_lshlrev_b32 v16, 2, v14
v_bfe_u32 v16, s74, v16, 4
v_add_u32 v16, v16, v15
v_add_u32 v16, v16, v12
v_lshlrev_b32 v16, 4, v16
v_mul_u32_u24 v17, 4352, v14
v_add_u32 v16, v16, v17
s_lshr_b32 s75, s4, 1
s_mul_i32 s76, s75, 35072
s_and_b32 s77, s4, 1
s_lshl_b32 s77, s77, 8
s_add_u32 s76, s76, s77
s_add_u32 s76, s76, 0
v_add_u32 v59, s76, v16
s_mul_i32 s76, s75, 4608
s_add_u32 s76, s76, s77
s_add_u32 s76, s76, 139744
v_lshlrev_b32 v16, 5, v11
v_lshlrev_b32 v17, 4, v12
s_add_u32 s92, s92, 4096
buffer_load_dwordx4 a[96:99], v58, s[36:39], s92 offen offset:0 sc1
v_sub_u32 v16, v17, v16
v_add_u32 v60, s76, v16
s_lshl_b32 s74, s5, 2
s_lshr_b32 s75, s4, 1
s_lshl_b32 s75, s75, 1
s_add_u32 s74, s74, s75
s_mul_i32 s74, s74, 112
s_lshl_b32 s75, s6, 3
s_add_u32 s74, s74, s75
s_and_b32 s75, s4, 1
s_lshl_b32 s75, s75, 2
s_add_u32 s74, s74, s75
s_lshl_b32 s74, s74, 10
s_add_u32 s93, s93, 4096
buffer_load_dwordx4 a[100:103], v58, s[36:39], s93 offen offset:0 sc1
s_add_u32 s78, s74, 5242880
s_add_u32 s79, s78, 114688
v_max_f32 v64, 0, v64
v_max_f32 v65, 0, v65
v_max_f32 v66, 0, v66
v_max_f32 v67, 0, v67
v_max_f32 v68, 0, v68
v_max_f32 v69, 0, v69
v_max_f32 v70, 0, v70
v_max_f32 v71, 0, v71
v_pk_mul_f32 v[64:65], v[64:65], v[64:65]
v_pk_mul_f32 v[66:67], v[66:67], v[66:67]
v_pk_mul_f32 v[68:69], v[68:69], v[68:69]
buffer_load_dwordx4 a[104:107], v58, s[36:39], s92 offen offset:2048 sc1
v_pk_mul_f32 v[70:71], v[70:71], v[70:71]
v_cvt_pk_bf16_f32 v160, v64, v65
v_cvt_pk_bf16_f32 v161, v66, v67
v_cvt_pk_bf16_f32 v162, v68, v69
v_cvt_pk_bf16_f32 v163, v70, v71
buffer_store_dwordx4 v[160:163], v58, s[36:39], s78 offen offset:0 sc1
v_max_f32 v72, 0, v72
v_max_f32 v73, 0, v73
v_max_f32 v74, 0, v74
v_max_f32 v75, 0, v75
v_max_f32 v76, 0, v76
v_max_f32 v77, 0, v77
v_max_f32 v78, 0, v78
v_max_f32 v79, 0, v79
v_pk_mul_f32 v[72:73], v[72:73], v[72:73]
v_pk_mul_f32 v[74:75], v[74:75], v[74:75]
v_pk_mul_f32 v[76:77], v[76:77], v[76:77]
v_pk_mul_f32 v[78:79], v[78:79], v[78:79]
v_cvt_pk_bf16_f32 v164, v72, v73
v_cvt_pk_bf16_f32 v165, v74, v75
v_cvt_pk_bf16_f32 v166, v76, v77
v_cvt_pk_bf16_f32 v167, v78, v79
buffer_store_dwordx4 v[164:167], v58, s[36:39], s78 offen offset:1024 sc1
v_max_f32 v96, 0, v96
v_max_f32 v97, 0, v97
v_max_f32 v98, 0, v98
v_max_f32 v99, 0, v99
v_max_f32 v100, 0, v100
v_max_f32 v101, 0, v101
v_max_f32 v102, 0, v102
v_max_f32 v103, 0, v103
v_pk_mul_f32 v[96:97], v[96:97], v[96:97]
v_pk_mul_f32 v[98:99], v[98:99], v[98:99]
v_pk_mul_f32 v[100:101], v[100:101], v[100:101]
v_pk_mul_f32 v[102:103], v[102:103], v[102:103]
v_cvt_pk_bf16_f32 v168, v96, v97
v_cvt_pk_bf16_f32 v169, v98, v99
v_cvt_pk_bf16_f32 v170, v100, v101
v_cvt_pk_bf16_f32 v171, v102, v103
buffer_store_dwordx4 v[168:171], v58, s[36:39], s78 offen offset:2048 sc1
v_max_f32 v104, 0, v104
v_max_f32 v105, 0, v105
v_max_f32 v106, 0, v106
v_max_f32 v107, 0, v107
v_max_f32 v108, 0, v108
v_max_f32 v109, 0, v109
v_max_f32 v110, 0, v110
v_max_f32 v111, 0, v111
v_pk_mul_f32 v[104:105], v[104:105], v[104:105]
v_pk_mul_f32 v[106:107], v[106:107], v[106:107]
v_pk_mul_f32 v[108:109], v[108:109], v[108:109]
v_pk_mul_f32 v[110:111], v[110:111], v[110:111]
v_cvt_pk_bf16_f32 v172, v104, v105
v_cvt_pk_bf16_f32 v173, v106, v107
v_cvt_pk_bf16_f32 v174, v108, v109
v_cvt_pk_bf16_f32 v175, v110, v111
buffer_store_dwordx4 v[172:175], v58, s[36:39], s78 offen offset:3072 sc1
v_max_f32 v80, 0, v80
v_max_f32 v81, 0, v81
v_max_f32 v82, 0, v82
v_max_f32 v83, 0, v83
v_max_f32 v84, 0, v84
v_max_f32 v85, 0, v85
v_max_f32 v86, 0, v86
v_max_f32 v87, 0, v87
v_pk_mul_f32 v[80:81], v[80:81], v[80:81]
v_pk_mul_f32 v[82:83], v[82:83], v[82:83]
v_pk_mul_f32 v[84:85], v[84:85], v[84:85]
v_pk_mul_f32 v[86:87], v[86:87], v[86:87]
v_cvt_pk_bf16_f32 v176, v80, v81
v_cvt_pk_bf16_f32 v177, v82, v83
v_cvt_pk_bf16_f32 v178, v84, v85
v_cvt_pk_bf16_f32 v179, v86, v87
buffer_store_dwordx4 v[176:179], v58, s[36:39], s79 offen offset:0 sc1
v_max_f32 v88, 0, v88
v_max_f32 v89, 0, v89
v_max_f32 v90, 0, v90
v_max_f32 v91, 0, v91
v_max_f32 v92, 0, v92
v_max_f32 v93, 0, v93
v_max_f32 v94, 0, v94
v_max_f32 v95, 0, v95
v_pk_mul_f32 v[88:89], v[88:89], v[88:89]
v_pk_mul_f32 v[90:91], v[90:91], v[90:91]
v_pk_mul_f32 v[92:93], v[92:93], v[92:93]
v_pk_mul_f32 v[94:95], v[94:95], v[94:95]
v_cvt_pk_bf16_f32 v180, v88, v89
v_cvt_pk_bf16_f32 v181, v90, v91
v_cvt_pk_bf16_f32 v182, v92, v93
v_cvt_pk_bf16_f32 v183, v94, v95
buffer_store_dwordx4 v[180:183], v58, s[36:39], s79 offen offset:1024 sc1
v_max_f32 v112, 0, v112
v_max_f32 v113, 0, v113
v_max_f32 v114, 0, v114
v_max_f32 v115, 0, v115
v_max_f32 v116, 0, v116
v_max_f32 v117, 0, v117
v_max_f32 v118, 0, v118
v_max_f32 v119, 0, v119
v_pk_mul_f32 v[112:113], v[112:113], v[112:113]
v_pk_mul_f32 v[114:115], v[114:115], v[114:115]
v_pk_mul_f32 v[116:117], v[116:117], v[116:117]
v_pk_mul_f32 v[118:119], v[118:119], v[118:119]
v_cvt_pk_bf16_f32 v184, v112, v113
v_cvt_pk_bf16_f32 v185, v114, v115
v_cvt_pk_bf16_f32 v186, v116, v117
v_cvt_pk_bf16_f32 v187, v118, v119
buffer_store_dwordx4 v[184:187], v58, s[36:39], s79 offen offset:2048 sc1
v_max_f32 v120, 0, v120
v_max_f32 v121, 0, v121
v_max_f32 v122, 0, v122
v_max_f32 v123, 0, v123
v_max_f32 v124, 0, v124
v_max_f32 v125, 0, v125
v_max_f32 v126, 0, v126
v_max_f32 v127, 0, v127
v_pk_mul_f32 v[120:121], v[120:121], v[120:121]
v_pk_mul_f32 v[122:123], v[122:123], v[122:123]
v_pk_mul_f32 v[124:125], v[124:125], v[124:125]
v_pk_mul_f32 v[126:127], v[126:127], v[126:127]
v_cvt_pk_bf16_f32 v188, v120, v121
v_cvt_pk_bf16_f32 v189, v122, v123
v_cvt_pk_bf16_f32 v190, v124, v125
v_cvt_pk_bf16_f32 v191, v126, v127
buffer_store_dwordx4 v[188:191], v58, s[36:39], s79 offen offset:3072 sc1
v_add_u32 v54, 139264, v46
s_waitcnt vmcnt(23)
ds_write_b128 v54, v[244:247] offset:0
ds_write_b128 v54, v[248:251] offset:4608
s_branch JOIN
GATE:
s_lshr_b32 s92, s2, 3
s_sub_u32 s92, s92, 28
s_mul_i32 s92, s92, 28
s_mul_i32 s93, s4, 7
s_add_u32 s92, s92, s93
s_and_b32 s93, s2, 7
s_lshl_b32 s21, s93, 7
s_add_u32 s21, s21, s92
s_lshl_b32 s21, s21, 11
s_add_u32 s21, s21, 3145728
s_lshl_b32 s93, s93, 7
s_lshl_b32 s92, s92, 14
s_add_u32 s93, s93, s92
v_and_b32 v23, 63, v0
v_lshrrev_b32 v19, 3, v23
v_and_b32 v20, 7, v23
v_bfe_u32 v21, v23, 4, 1
v_lshlrev_b32 v21, 2, v21
v_xor_b32 v20, v20, v21
v_lshlrev_b32 v20, 4, v20
v_lshl_add_u32 v19, v19, 10, v20
s_mul_i32 s92, s4, 14336
s_add_u32 s92, s92, 73728
v_and_b32 v20, 15, v23
v_lshrrev_b32 v21, 5, v23
v_lshrrev_b32 v22, 2, v20
v_lshl_add_u32 v21, v21, 2, v22
v_lshlrev_b32 v21, 7, v21
v_bfe_u32 v22, v23, 4, 1
v_lshlrev_b32 v22, 1, v22
v_bfe_u32 v24, v20, 1, 1
v_add_u32 v22, v22, v24
v_bfe_u32 v24, v20, 3, 1
v_lshl_add_u32 v22, v24, 2, v22
v_lshl_add_u32 v21, v22, 4, v21
v_and_b32 v24, 1, v20
v_lshl_add_u32 v20, v24, 3, v21
v_add_u32 v20, s92, v20
v_xor_b32 v21, 64, v20
v_lshlrev_b32 v22, 4, v23
s_lshr_b32 s84, s2, 5
s_and_b32 s85, s2, 31
s_lshl_b32 s85, s85, 6
s_and_b32 s74, s4, 1
s_lshr_b32 s75, s4, 1
s_lshl_b32 s76, s74, 5
s_add_u32 s76, s76, s85
s_sub_u32 s77, s76, 3
s_lshl_b32 s77, s77, 10
s_lshl_b32 s78, s84, 7
s_add_u32 s77, s77, s78
s_lshl_b32 s78, s75, 6
s_add_u32 s77, s77, s78
v_and_b32 v15, 15, v0
v_bfe_u32 v16, v0, 4, 2
v_lshlrev_b32 v10, 13, v16
v_lshl_add_u32 v10, v15, 2, v10
v_add_u32 v10, s77, v10
v_add_u32 v11, 1024, v10
v_add_u32 v12, 2048, v10
v_add_u32 v13, 3072, v10
v_add_u32 v14, 7168, v10
v_lshlrev_b32 v17, 4, v15
s_lshl_b32 s78, s84, 9
s_lshl_b32 s79, s75, 8
s_add_u32 s7, s78, s79
v_sub_u32 v16, 3, v16
v_lshlrev_b32 v16, 4, v16
v_lshl_add_u32 v18, v15, 13, v16
s_lshl_b32 s78, s84, 18
s_lshl_b32 s79, s75, 17
s_add_u32 s78, s78, s79
s_sub_u32 s79, 2016, s76
s_lshl_b32 s79, s79, 1
s_add_u32 s78, s78, s79
s_add_u32 s95, s78, 1048576
s_mov_b32 s10, 2097152
s_mov_b32 s11, 0x00020000
s_mov_b32 s26, 1835008
s_mov_b32 s27, 0x00020000
s_mov_b32 s14, 2097152
s_mov_b32 s15, 0x00020000
s_mov_b32 s18, 2097152
s_mov_b32 s19, 0x00020000
s_mov_b32 s30, 1835008
s_mov_b32 s31, 0x00020000
s_mov_b32 s34, 2097152
s_mov_b32 s35, 0x00020000
s_mov_b32 s38, 33554432
s_mov_b32 s39, 0x00020000
s_mov_b32 s43, 0x00020000
s_waitcnt lgkmcnt(0)
s_mov_b32 s8, s44
s_mov_b32 s9, s45
s_mov_b32 s12, s46
s_mov_b32 s13, s47
s_mov_b32 s16, s48
s_mov_b32 s17, s49
s_mov_b32 s28, s62
s_mov_b32 s29, s63
s_mov_b32 s32, s68
s_mov_b32 s33, s69
s_mov_b32 s36, s72
s_mov_b32 s37, s73
s_add_u32 m0, s92, 0
s_add_u32 s22, s93, 0
buffer_load_dwordx4 v19, s[28:31], s22 offen lds
s_add_u32 m0, s92, 1024
s_add_u32 s22, s93, 8192
buffer_load_dwordx4 v19, s[28:31], s22 offen lds
s_add_u32 m0, s92, 2048
s_add_u32 s22, s93, 16384
buffer_load_dwordx4 v19, s[28:31], s22 offen lds
s_add_u32 m0, s92, 3072
s_add_u32 s22, s93, 24576
buffer_load_dwordx4 v19, s[28:31], s22 offen lds
s_add_u32 m0, s92, 4096
s_add_u32 s22, s93, 32768
buffer_load_dwordx4 v19, s[28:31], s22 offen lds
s_add_u32 m0, s92, 5120
s_add_u32 s22, s93, 40960
buffer_load_dwordx4 v19, s[28:31], s22 offen lds
s_add_u32 m0, s92, 6144
s_add_u32 s22, s93, 49152
buffer_load_dwordx4 v19, s[28:31], s22 offen lds
s_add_u32 m0, s92, 7168
s_add_u32 s22, s93, 57344
buffer_load_dwordx4 v19, s[28:31], s22 offen lds
s_add_u32 m0, s92, 8192
s_add_u32 s22, s93, 65536
buffer_load_dwordx4 v19, s[28:31], s22 offen lds
s_add_u32 m0, s92, 9216
s_add_u32 s22, s93, 73728
buffer_load_dwordx4 v19, s[28:31], s22 offen lds
s_add_u32 m0, s92, 10240
s_add_u32 s22, s93, 81920
buffer_load_dwordx4 v19, s[28:31], s22 offen lds
s_add_u32 m0, s92, 11264
s_add_u32 s22, s93, 90112
buffer_load_dwordx4 v19, s[28:31], s22 offen lds
s_add_u32 m0, s92, 12288
s_add_u32 s22, s93, 98304
buffer_load_dwordx4 v19, s[28:31], s22 offen lds
s_add_u32 m0, s92, 13312
s_add_u32 s22, s93, 106496
buffer_load_dwordx4 v19, s[28:31], s22 offen lds
s_load_dword s96, s[72:73], 98304
s_lshl_b32 s74, s2, 2
s_load_dword s23, s[54:55], s74
s_mov_b32 s40, s50
s_mov_b32 s41, s51
s_mov_b32 s42, 4096
buffer_load_dwordx4 v[244:247], v17, s[40:43], s7 offen
buffer_load_dword v224, v10, s[12:15], 0 offen offset:0
buffer_load_dword v225, v11, s[12:15], 0 offen offset:0
buffer_load_dword v226, v12, s[12:15], 0 offen offset:0
buffer_load_dword v227, v13, s[12:15], 0 offen offset:0
buffer_load_dword v228, v13, s[12:15], 0 offen offset:1024
buffer_load_dword v229, v13, s[12:15], 0 offen offset:2048
buffer_load_dword v230, v13, s[12:15], 0 offen offset:3072
buffer_load_dword v231, v14, s[12:15], 0 offen offset:0
buffer_load_dword v232, v14, s[12:15], 0 offen offset:1024
buffer_load_dword v233, v14, s[12:15], 0 offen offset:2048
buffer_load_dword v234, v14, s[12:15], 0 offen offset:3072
buffer_load_dword v235, v13, s[16:19], 0 offen offset:0
buffer_load_dword v236, v13, s[16:19], 0 offen offset:1024
buffer_load_dword v237, v13, s[16:19], 0 offen offset:2048
buffer_load_dword v238, v13, s[16:19], 0 offen offset:3072
buffer_load_dword v239, v14, s[16:19], 0 offen offset:0
buffer_load_dword v240, v14, s[16:19], 0 offen offset:1024
buffer_load_dword v241, v14, s[16:19], 0 offen offset:2048
buffer_load_dword v242, v14, s[16:19], 0 offen offset:3072
s_lshl_b32 s74, s2, 13
s_add_u32 s84, s52, s74
s_addc_u32 s85, s53, 0
s_mov_b32 s86, 4096
s_mov_b32 s87, 0x00020000
s_add_u32 s74, s74, 4096
s_add_u32 s88, s52, s74
s_addc_u32 s89, s53, 0
s_mov_b32 s90, 4096
s_mov_b32 s91, 0x00020000
v_lshlrev_b32 v46, 4, v0
v_add_u32 v47, -16, v46
s_waitcnt vmcnt(32)
ds_read_b64_tr_b16 v[64:65], v20 offset:0
ds_read_b64_tr_b16 v[66:67], v20 offset:1024
ds_read_b64_tr_b16 v[68:69], v21 offset:0
ds_read_b64_tr_b16 v[70:71], v21 offset:1024
s_waitcnt vmcnt(30)
ds_read_b64_tr_b16 v[72:73], v20 offset:2048
ds_read_b64_tr_b16 v[74:75], v20 offset:3072
ds_read_b64_tr_b16 v[76:77], v21 offset:2048
ds_read_b64_tr_b16 v[78:79], v21 offset:3072
s_waitcnt vmcnt(28)
ds_read_b64_tr_b16 v[80:81], v20 offset:4096
ds_read_b64_tr_b16 v[82:83], v20 offset:5120
ds_read_b64_tr_b16 v[84:85], v21 offset:4096
ds_read_b64_tr_b16 v[86:87], v21 offset:5120
s_waitcnt vmcnt(26)
ds_read_b64_tr_b16 v[88:89], v20 offset:6144
ds_read_b64_tr_b16 v[90:91], v20 offset:7168
ds_read_b64_tr_b16 v[92:93], v21 offset:6144
ds_read_b64_tr_b16 v[94:95], v21 offset:7168
s_waitcnt vmcnt(24)
ds_read_b64_tr_b16 v[96:97], v20 offset:8192
ds_read_b64_tr_b16 v[98:99], v20 offset:9216
ds_read_b64_tr_b16 v[100:101], v21 offset:8192
ds_read_b64_tr_b16 v[102:103], v21 offset:9216
s_waitcnt vmcnt(22)
ds_read_b64_tr_b16 v[104:105], v20 offset:10240
ds_read_b64_tr_b16 v[106:107], v20 offset:11264
ds_read_b64_tr_b16 v[108:109], v21 offset:10240
ds_read_b64_tr_b16 v[110:111], v21 offset:11264
s_waitcnt vmcnt(20)
ds_read_b64_tr_b16 v[112:113], v20 offset:12288
ds_read_b64_tr_b16 v[114:115], v20 offset:13312
ds_read_b64_tr_b16 v[116:117], v21 offset:12288
ds_read_b64_tr_b16 v[118:119], v21 offset:13312
s_waitcnt lgkmcnt(15)
buffer_store_dwordx4 v[64:67], v22, s[36:39], s21 offen offset:0 sc1
buffer_store_dwordx4 v[68:71], v22, s[36:39], s21 offen offset:1024 sc1
buffer_store_dwordx4 v[72:75], v22, s[36:39], s21 offen offset:2048 sc1
buffer_store_dwordx4 v[76:79], v22, s[36:39], s21 offen offset:3072 sc1
s_add_u32 s21, s21, 4096
buffer_store_dwordx4 v[80:83], v22, s[36:39], s21 offen offset:0 sc1
buffer_store_dwordx4 v[84:87], v22, s[36:39], s21 offen offset:1024 sc1
s_waitcnt lgkmcnt(12)
buffer_store_dwordx4 v[88:91], v22, s[36:39], s21 offen offset:2048 sc1
buffer_store_dwordx4 v[92:95], v22, s[36:39], s21 offen offset:3072 sc1
s_waitcnt lgkmcnt(8)
s_add_u32 s21, s21, 4096
buffer_store_dwordx4 v[96:99], v22, s[36:39], s21 offen offset:0 sc1
buffer_store_dwordx4 v[100:103], v22, s[36:39], s21 offen offset:1024 sc1
s_waitcnt lgkmcnt(4)
buffer_store_dwordx4 v[104:107], v22, s[36:39], s21 offen offset:2048 sc1
buffer_store_dwordx4 v[108:111], v22, s[36:39], s21 offen offset:3072 sc1
s_waitcnt lgkmcnt(0)
s_add_u32 s21, s21, 4096
buffer_store_dwordx4 v[112:115], v22, s[36:39], s21 offen offset:0 sc1
buffer_store_dwordx4 v[116:119], v22, s[36:39], s21 offen offset:1024 sc1
s_waitcnt vmcnt(14)
v_lshlrev_b32 v150, 16, v244
v_lshlrev_b32 v151, 16, v246
v_and_b32 v152, 0xffff0000, v244
v_and_b32 v153, 0xffff0000, v246
v_lshlrev_b32 v154, 16, v245
v_lshlrev_b32 v155, 16, v247
v_and_b32 v156, 0xffff0000, v245
v_and_b32 v157, 0xffff0000, v247
v_lshlrev_b32 v128, 16, v224
v_and_b32 v129, 0xffff0000, v224
v_lshlrev_b32 v130, 16, v225
v_and_b32 v131, 0xffff0000, v225
v_lshlrev_b32 v132, 16, v226
v_and_b32 v133, 0xffff0000, v226
v_lshlrev_b32 v134, 16, v227
v_and_b32 v135, 0xffff0000, v227
v_lshlrev_b32 v136, 16, v228
v_and_b32 v137, 0xffff0000, v228
v_lshlrev_b32 v138, 16, v229
v_and_b32 v139, 0xffff0000, v229
v_lshlrev_b32 v140, 16, v230
v_and_b32 v141, 0xffff0000, v230
v_lshlrev_b32 v142, 16, v231
v_and_b32 v143, 0xffff0000, v231
v_lshlrev_b32 v144, 16, v232
v_and_b32 v145, 0xffff0000, v232
v_lshlrev_b32 v146, 16, v233
v_and_b32 v147, 0xffff0000, v233
v_lshlrev_b32 v148, 16, v234
v_and_b32 v149, 0xffff0000, v234
v_pk_mul_f32 v[30:31], v[134:135], v[150:151]
v_pk_mul_f32 v[32:33], v[136:137], v[150:151]
v_pk_mul_f32 v[34:35], v[138:139], v[150:151]
v_pk_mul_f32 v[36:37], v[140:141], v[150:151]
v_pk_mul_f32 v[38:39], v[142:143], v[150:151]
v_pk_mul_f32 v[40:41], v[144:145], v[150:151]
v_pk_mul_f32 v[42:43], v[146:147], v[150:151]
v_pk_mul_f32 v[44:45], v[148:149], v[150:151]
v_pk_fma_f32 v[30:31], v[132:133], v[152:153], v[30:31]
v_pk_fma_f32 v[32:33], v[134:135], v[152:153], v[32:33]
v_pk_fma_f32 v[34:35], v[136:137], v[152:153], v[34:35]
v_pk_fma_f32 v[36:37], v[138:139], v[152:153], v[36:37]
v_pk_fma_f32 v[38:39], v[140:141], v[152:153], v[38:39]
v_pk_fma_f32 v[40:41], v[142:143], v[152:153], v[40:41]
v_pk_fma_f32 v[42:43], v[144:145], v[152:153], v[42:43]
v_pk_fma_f32 v[44:45], v[146:147], v[152:153], v[44:45]
v_pk_fma_f32 v[30:31], v[130:131], v[154:155], v[30:31]
v_pk_fma_f32 v[32:33], v[132:133], v[154:155], v[32:33]
v_pk_fma_f32 v[34:35], v[134:135], v[154:155], v[34:35]
v_pk_fma_f32 v[36:37], v[136:137], v[154:155], v[36:37]
v_pk_fma_f32 v[38:39], v[138:139], v[154:155], v[38:39]
v_pk_fma_f32 v[40:41], v[140:141], v[154:155], v[40:41]
v_pk_fma_f32 v[42:43], v[142:143], v[154:155], v[42:43]
v_pk_fma_f32 v[44:45], v[144:145], v[154:155], v[44:45]
v_pk_fma_f32 v[30:31], v[128:129], v[156:157], v[30:31]
v_pk_fma_f32 v[32:33], v[130:131], v[156:157], v[32:33]
v_pk_fma_f32 v[34:35], v[132:133], v[156:157], v[34:35]
v_pk_fma_f32 v[36:37], v[134:135], v[156:157], v[36:37]
v_pk_fma_f32 v[38:39], v[136:137], v[156:157], v[38:39]
v_pk_fma_f32 v[40:41], v[138:139], v[156:157], v[40:41]
v_pk_fma_f32 v[42:43], v[140:141], v[156:157], v[42:43]
v_pk_fma_f32 v[44:45], v[142:143], v[156:157], v[44:45]
v_lshlrev_b32 v128, 16, v235
v_and_b32 v129, 0xffff0000, v235
v_lshlrev_b32 v130, 16, v236
v_and_b32 v131, 0xffff0000, v236
v_lshlrev_b32 v132, 16, v237
v_and_b32 v133, 0xffff0000, v237
v_lshlrev_b32 v134, 16, v238
v_and_b32 v135, 0xffff0000, v238
v_lshlrev_b32 v136, 16, v239
v_and_b32 v137, 0xffff0000, v239
v_lshlrev_b32 v138, 16, v240
v_and_b32 v139, 0xffff0000, v240
v_lshlrev_b32 v140, 16, v241
v_and_b32 v141, 0xffff0000, v241
v_lshlrev_b32 v142, 16, v242
v_and_b32 v143, 0xffff0000, v242
v_pk_mul_f32 v[30:31], v[30:31], v[128:129]
v_pk_mul_f32 v[32:33], v[32:33], v[130:131]
v_pk_mul_f32 v[34:35], v[34:35], v[132:133]
v_pk_mul_f32 v[36:37], v[36:37], v[134:135]
v_pk_mul_f32 v[38:39], v[38:39], v[136:137]
v_pk_mul_f32 v[40:41], v[40:41], v[138:139]
v_pk_mul_f32 v[42:43], v[42:43], v[140:141]
v_pk_mul_f32 v[44:45], v[44:45], v[142:143]
v_cvt_pk_bf16_f32 v144, v44, v42
v_cvt_pk_bf16_f32 v145, v40, v38
v_cvt_pk_bf16_f32 v146, v36, v34
v_cvt_pk_bf16_f32 v147, v32, v30
buffer_store_dwordx4 v[144:147], v18, s[36:39], s95 offen sc1
v_cvt_pk_bf16_f32 v148, v45, v43
v_cvt_pk_bf16_f32 v149, v41, v39
v_cvt_pk_bf16_f32 v150, v37, v35
v_cvt_pk_bf16_f32 v151, v33, v31
s_add_u32 s95, s95, 4096
buffer_store_dwordx4 v[148:151], v18, s[36:39], s95 offen sc1
v_mov_b32 v48, 0
v_mov_b32 v49, 0
v_mov_b32 v50, 0
v_mov_b32 v51, 0
v_add_u32 v52, 143360, v46
v_cmp_gt_u32 vcc, 32, v0
s_and_saveexec_b64 s[74:75], vcc
ds_write_b128 v52, v[48:51] offset:0
ds_write_b128 v52, v[48:51] offset:4608
s_mov_b64 exec, s[74:75]
v_and_b32 v58, 63, v0
s_lshr_b32 s75, s2, 5
s_lshl_b32 s74, s75, 5
v_and_b32 v59, 31, v58
v_add_u32 v61, s74, v59
v_and_b32 v60, 3, v58
v_lshlrev_b32 v60, 3, v60
s_add_u32 s75, s75, 800
v_add_u32 v60, s75, v60
v_cmp_gt_u32 vcc, 32, v58
s_nop 1
v_cndmask_b32 v56, v60, v61, vcc
v_lshlrev_b32 v56, 7, v56
v_add_u32 v61, 256, v61
v_add_u32 v59, 224, v59
v_cndmask_b32 v61, v59, v61, vcc
v_lshlrev_b32 v61, 7, v61
s_and_b32 s74, s2, 7
s_lshl_b32 s74, s74, 2
s_lshr_b32 s75, s2, 3
s_and_b32 s75, s75, 3
s_add_u32 s74, s74, s75
s_lshr_b32 s75, s74, 1
s_lshr_b32 s76, s75, 2
s_lshl_b32 s76, s76, 1
s_and_b32 s77, s75, 3
s_lshl_b32 s77, s77, 3
s_add_u32 s76, s76, s77
v_cmp_lt_u32 vcc, 6, v58
s_nop 1
v_cndmask_b32 v59, 0, 1, vcc
v_mul_u32_u24 v60, 7, v59
v_sub_u32 v60, v58, v60
v_lshlrev_b32 v60, 5, v60
v_add_u32 v60, v60, v59
v_cmp_gt_u32 vcc, 14, v58
s_nop 1
v_cndmask_b32 v60, 0, v60, vcc
v_add_u32 v60, s76, v60
v_lshlrev_b32 v57, 7, v60
s_cmp_eq_u32 s4, 0
s_cselect_b32 s74, 0, 1073741824
v_or_b32 v56, s74, v56
v_or_b32 v57, s74, v57
v_or_b32 v61, s74, v61
v_lshlrev_b32 v58, 4, v58
s_waitcnt lgkmcnt(0)
s_mul_i32 s3, s96, 0x9E3779B1
s_add_u32 s3, s3, 0x85EBCA6B
s_waitcnt vmcnt(2)
s_barrier
s_cmp_eq_u32 s4, 0
s_cbranch_scc0 PUB_6
s_lshl_b32 s97, s2, 7
s_add_u32 s97, s97, 73728
v_mov_b32 v62, s3
s_mov_b64 exec, 1
buffer_store_dword v62, off, s[36:39], s97 sc1
s_mov_b64 exec, -1
PUB_6:
s_waitcnt vmcnt(0)
s_barrier
s_cmp_eq_u32 s4, 0
s_cbranch_scc0 PUB_7
s_lshl_b32 s97, s2, 7
s_add_u32 s97, s97, 0
v_mov_b32 v62, s3
s_mov_b64 exec, 1
buffer_store_dword v62, off, s[36:39], s97 sc1
s_mov_b64 exec, -1
PUB_7:
s_and_b32 s5, s2, 7
s_lshl_b32 s5, s5, 2
s_lshr_b32 s6, s2, 3
s_sub_u32 s6, s6, 28
s_add_u32 s5, s5, s6
s_lshl_b32 s5, s5, 6
s_lshl_b32 s6, s4, 4
s_add_u32 s5, s5, s6
s_lshl_b32 s6, s5, 10
s_mov_b32 s40, s66
s_mov_b32 s41, s67
s_mov_b32 s42, 1024
buffer_load_dwordx4 v[4:7], v22, s[40:43], 0 offen
buffer_load_dwordx4 a[0:3], v22, s[8:11], s6 offen offset:0
buffer_load_dwordx4 a[4:7], v22, s[8:11], s6 offen offset:1024
buffer_load_dwordx4 a[8:11], v22, s[8:11], s6 offen offset:2048
buffer_load_dwordx4 a[12:15], v22, s[8:11], s6 offen offset:3072
s_add_u32 s6, s6, 4096
buffer_load_dwordx4 a[16:19], v22, s[8:11], s6 offen offset:0
buffer_load_dwordx4 a[20:23], v22, s[8:11], s6 offen offset:1024
buffer_load_dwordx4 a[24:27], v22, s[8:11], s6 offen offset:2048
buffer_load_dwordx4 a[28:31], v22, s[8:11], s6 offen offset:3072
s_add_u32 s6, s6, 4096
buffer_load_dwordx4 a[32:35], v22, s[8:11], s6 offen offset:0
buffer_load_dwordx4 a[36:39], v22, s[8:11], s6 offen offset:1024
buffer_load_dwordx4 a[40:43], v22, s[8:11], s6 offen offset:2048
buffer_load_dwordx4 a[44:47], v22, s[8:11], s6 offen offset:3072
s_add_u32 s6, s6, 4096
buffer_load_dwordx4 a[48:51], v22, s[8:11], s6 offen offset:0
buffer_load_dwordx4 a[52:55], v22, s[8:11], s6 offen offset:1024
buffer_load_dwordx4 a[56:59], v22, s[8:11], s6 offen offset:2048
buffer_load_dwordx4 a[60:63], v22, s[8:11], s6 offen offset:3072
buffer_load_dwordx4 v[30:33], v47, s[84:87], 0 offen
buffer_load_dwordx4 v[34:37], v46, s[84:87], 0 offen
buffer_load_dwordx4 v[38:41], v47, s[88:91], 0 offen
buffer_load_dwordx4 v[42:45], v46, s[88:91], 0 offen
s_waitcnt vmcnt(20)
v_lshlrev_b32 v8, 16, v4
v_and_b32 v9, 0xffff0000, v4
v_lshlrev_b32 v10, 16, v5
v_and_b32 v11, 0xffff0000, v5
v_lshlrev_b32 v12, 16, v6
v_and_b32 v13, 0xffff0000, v6
v_lshlrev_b32 v14, 16, v7
v_and_b32 v15, 0xffff0000, v7
s_waitcnt vmcnt(19)
v_accvgpr_read_b32 v64, a0
v_accvgpr_read_b32 v65, a1
v_accvgpr_read_b32 v66, a2
v_accvgpr_read_b32 v67, a3
v_lshlrev_b32 v72, 16, v64
v_and_b32 v73, 0xffff0000, v64
v_lshlrev_b32 v74, 16, v65
v_and_b32 v75, 0xffff0000, v65
v_lshlrev_b32 v76, 16, v66
v_and_b32 v77, 0xffff0000, v66
v_lshlrev_b32 v78, 16, v67
v_and_b32 v79, 0xffff0000, v67
v_pk_mul_f32 v[88:89], v[72:73], v[8:9]
v_pk_fma_f32 v[88:89], v[74:75], v[10:11], v[88:89]
v_pk_fma_f32 v[88:89], v[76:77], v[12:13], v[88:89]
v_pk_fma_f32 v[88:89], v[78:79], v[14:15], v[88:89]
v_add_f32 v96, v88, v89
s_waitcnt vmcnt(18)
v_accvgpr_read_b32 v68, a4
v_accvgpr_read_b32 v69, a5
v_accvgpr_read_b32 v70, a6
v_accvgpr_read_b32 v71, a7
v_lshlrev_b32 v80, 16, v68
v_and_b32 v81, 0xffff0000, v68
v_lshlrev_b32 v82, 16, v69
v_and_b32 v83, 0xffff0000, v69
v_lshlrev_b32 v84, 16, v70
v_and_b32 v85, 0xffff0000, v70
v_lshlrev_b32 v86, 16, v71
v_and_b32 v87, 0xffff0000, v71
v_pk_mul_f32 v[90:91], v[80:81], v[8:9]
v_pk_fma_f32 v[90:91], v[82:83], v[10:11], v[90:91]
v_pk_fma_f32 v[90:91], v[84:85], v[12:13], v[90:91]
v_pk_fma_f32 v[90:91], v[86:87], v[14:15], v[90:91]
v_add_f32 v97, v90, v91
s_waitcnt vmcnt(17)
v_accvgpr_read_b32 v64, a8
v_accvgpr_read_b32 v65, a9
v_accvgpr_read_b32 v66, a10
v_accvgpr_read_b32 v67, a11
v_lshlrev_b32 v72, 16, v64
v_and_b32 v73, 0xffff0000, v64
v_lshlrev_b32 v74, 16, v65
v_and_b32 v75, 0xffff0000, v65
v_lshlrev_b32 v76, 16, v66
v_and_b32 v77, 0xffff0000, v66
v_lshlrev_b32 v78, 16, v67
v_and_b32 v79, 0xffff0000, v67
v_pk_mul_f32 v[88:89], v[72:73], v[8:9]
v_pk_fma_f32 v[88:89], v[74:75], v[10:11], v[88:89]
v_pk_fma_f32 v[88:89], v[76:77], v[12:13], v[88:89]
v_pk_fma_f32 v[88:89], v[78:79], v[14:15], v[88:89]
v_add_f32 v98, v88, v89
s_waitcnt vmcnt(16)
v_accvgpr_read_b32 v68, a12
v_accvgpr_read_b32 v69, a13
v_accvgpr_read_b32 v70, a14
v_accvgpr_read_b32 v71, a15
v_lshlrev_b32 v80, 16, v68
v_and_b32 v81, 0xffff0000, v68
v_lshlrev_b32 v82, 16, v69
v_and_b32 v83, 0xffff0000, v69
v_lshlrev_b32 v84, 16, v70
v_and_b32 v85, 0xffff0000, v70
v_lshlrev_b32 v86, 16, v71
v_and_b32 v87, 0xffff0000, v71
v_pk_mul_f32 v[90:91], v[80:81], v[8:9]
v_pk_fma_f32 v[90:91], v[82:83], v[10:11], v[90:91]
v_pk_fma_f32 v[90:91], v[84:85], v[12:13], v[90:91]
v_pk_fma_f32 v[90:91], v[86:87], v[14:15], v[90:91]
v_add_f32 v99, v90, v91
s_waitcnt vmcnt(15)
v_accvgpr_read_b32 v64, a16
v_accvgpr_read_b32 v65, a17
v_accvgpr_read_b32 v66, a18
v_accvgpr_read_b32 v67, a19
v_lshlrev_b32 v72, 16, v64
v_and_b32 v73, 0xffff0000, v64
v_lshlrev_b32 v74, 16, v65
v_and_b32 v75, 0xffff0000, v65
v_lshlrev_b32 v76, 16, v66
v_and_b32 v77, 0xffff0000, v66
v_lshlrev_b32 v78, 16, v67
v_and_b32 v79, 0xffff0000, v67
v_pk_mul_f32 v[88:89], v[72:73], v[8:9]
v_pk_fma_f32 v[88:89], v[74:75], v[10:11], v[88:89]
v_pk_fma_f32 v[88:89], v[76:77], v[12:13], v[88:89]
v_pk_fma_f32 v[88:89], v[78:79], v[14:15], v[88:89]
v_add_f32 v100, v88, v89
s_waitcnt vmcnt(14)
v_accvgpr_read_b32 v68, a20
v_accvgpr_read_b32 v69, a21
v_accvgpr_read_b32 v70, a22
v_accvgpr_read_b32 v71, a23
v_lshlrev_b32 v80, 16, v68
v_and_b32 v81, 0xffff0000, v68
v_lshlrev_b32 v82, 16, v69
v_and_b32 v83, 0xffff0000, v69
v_lshlrev_b32 v84, 16, v70
v_and_b32 v85, 0xffff0000, v70
v_lshlrev_b32 v86, 16, v71
v_and_b32 v87, 0xffff0000, v71
v_pk_mul_f32 v[90:91], v[80:81], v[8:9]
v_pk_fma_f32 v[90:91], v[82:83], v[10:11], v[90:91]
v_pk_fma_f32 v[90:91], v[84:85], v[12:13], v[90:91]
v_pk_fma_f32 v[90:91], v[86:87], v[14:15], v[90:91]
v_add_f32 v101, v90, v91
s_waitcnt vmcnt(13)
v_accvgpr_read_b32 v64, a24
v_accvgpr_read_b32 v65, a25
v_accvgpr_read_b32 v66, a26
v_accvgpr_read_b32 v67, a27
v_lshlrev_b32 v72, 16, v64
v_and_b32 v73, 0xffff0000, v64
v_lshlrev_b32 v74, 16, v65
v_and_b32 v75, 0xffff0000, v65
v_lshlrev_b32 v76, 16, v66
v_and_b32 v77, 0xffff0000, v66
v_lshlrev_b32 v78, 16, v67
v_and_b32 v79, 0xffff0000, v67
v_pk_mul_f32 v[88:89], v[72:73], v[8:9]
v_pk_fma_f32 v[88:89], v[74:75], v[10:11], v[88:89]
v_pk_fma_f32 v[88:89], v[76:77], v[12:13], v[88:89]
v_pk_fma_f32 v[88:89], v[78:79], v[14:15], v[88:89]
v_add_f32 v102, v88, v89
s_waitcnt vmcnt(12)
v_accvgpr_read_b32 v68, a28
v_accvgpr_read_b32 v69, a29
v_accvgpr_read_b32 v70, a30
v_accvgpr_read_b32 v71, a31
v_lshlrev_b32 v80, 16, v68
v_and_b32 v81, 0xffff0000, v68
v_lshlrev_b32 v82, 16, v69
v_and_b32 v83, 0xffff0000, v69
v_lshlrev_b32 v84, 16, v70
v_and_b32 v85, 0xffff0000, v70
v_lshlrev_b32 v86, 16, v71
v_and_b32 v87, 0xffff0000, v71
v_pk_mul_f32 v[90:91], v[80:81], v[8:9]
v_pk_fma_f32 v[90:91], v[82:83], v[10:11], v[90:91]
v_pk_fma_f32 v[90:91], v[84:85], v[12:13], v[90:91]
v_pk_fma_f32 v[90:91], v[86:87], v[14:15], v[90:91]
v_add_f32 v103, v90, v91
s_waitcnt vmcnt(11)
v_accvgpr_read_b32 v64, a32
v_accvgpr_read_b32 v65, a33
v_accvgpr_read_b32 v66, a34
v_accvgpr_read_b32 v67, a35
v_lshlrev_b32 v72, 16, v64
v_and_b32 v73, 0xffff0000, v64
v_lshlrev_b32 v74, 16, v65
v_and_b32 v75, 0xffff0000, v65
v_lshlrev_b32 v76, 16, v66
v_and_b32 v77, 0xffff0000, v66
v_lshlrev_b32 v78, 16, v67
v_and_b32 v79, 0xffff0000, v67
v_pk_mul_f32 v[88:89], v[72:73], v[8:9]
v_pk_fma_f32 v[88:89], v[74:75], v[10:11], v[88:89]
v_pk_fma_f32 v[88:89], v[76:77], v[12:13], v[88:89]
v_pk_fma_f32 v[88:89], v[78:79], v[14:15], v[88:89]
v_add_f32 v104, v88, v89
s_waitcnt vmcnt(10)
v_accvgpr_read_b32 v68, a36
v_accvgpr_read_b32 v69, a37
v_accvgpr_read_b32 v70, a38
v_accvgpr_read_b32 v71, a39
v_lshlrev_b32 v80, 16, v68
v_and_b32 v81, 0xffff0000, v68
v_lshlrev_b32 v82, 16, v69
v_and_b32 v83, 0xffff0000, v69
v_lshlrev_b32 v84, 16, v70
v_and_b32 v85, 0xffff0000, v70
v_lshlrev_b32 v86, 16, v71
v_and_b32 v87, 0xffff0000, v71
v_pk_mul_f32 v[90:91], v[80:81], v[8:9]
v_pk_fma_f32 v[90:91], v[82:83], v[10:11], v[90:91]
v_pk_fma_f32 v[90:91], v[84:85], v[12:13], v[90:91]
v_pk_fma_f32 v[90:91], v[86:87], v[14:15], v[90:91]
v_add_f32 v105, v90, v91
s_waitcnt vmcnt(9)
v_accvgpr_read_b32 v64, a40
v_accvgpr_read_b32 v65, a41
v_accvgpr_read_b32 v66, a42
v_accvgpr_read_b32 v67, a43
v_lshlrev_b32 v72, 16, v64
v_and_b32 v73, 0xffff0000, v64
v_lshlrev_b32 v74, 16, v65
v_and_b32 v75, 0xffff0000, v65
v_lshlrev_b32 v76, 16, v66
v_and_b32 v77, 0xffff0000, v66
v_lshlrev_b32 v78, 16, v67
v_and_b32 v79, 0xffff0000, v67
v_pk_mul_f32 v[88:89], v[72:73], v[8:9]
v_pk_fma_f32 v[88:89], v[74:75], v[10:11], v[88:89]
v_pk_fma_f32 v[88:89], v[76:77], v[12:13], v[88:89]
v_pk_fma_f32 v[88:89], v[78:79], v[14:15], v[88:89]
v_add_f32 v106, v88, v89
s_waitcnt vmcnt(8)
v_accvgpr_read_b32 v68, a44
v_accvgpr_read_b32 v69, a45
v_accvgpr_read_b32 v70, a46
v_accvgpr_read_b32 v71, a47
v_lshlrev_b32 v80, 16, v68
v_and_b32 v81, 0xffff0000, v68
v_lshlrev_b32 v82, 16, v69
v_and_b32 v83, 0xffff0000, v69
v_lshlrev_b32 v84, 16, v70
v_and_b32 v85, 0xffff0000, v70
v_lshlrev_b32 v86, 16, v71
v_and_b32 v87, 0xffff0000, v71
v_pk_mul_f32 v[90:91], v[80:81], v[8:9]
v_pk_fma_f32 v[90:91], v[82:83], v[10:11], v[90:91]
v_pk_fma_f32 v[90:91], v[84:85], v[12:13], v[90:91]
v_pk_fma_f32 v[90:91], v[86:87], v[14:15], v[90:91]
v_add_f32 v107, v90, v91
s_waitcnt vmcnt(7)
v_accvgpr_read_b32 v64, a48
v_accvgpr_read_b32 v65, a49
v_accvgpr_read_b32 v66, a50
v_accvgpr_read_b32 v67, a51
v_lshlrev_b32 v72, 16, v64
v_and_b32 v73, 0xffff0000, v64
v_lshlrev_b32 v74, 16, v65
v_and_b32 v75, 0xffff0000, v65
v_lshlrev_b32 v76, 16, v66
v_and_b32 v77, 0xffff0000, v66
v_lshlrev_b32 v78, 16, v67
v_and_b32 v79, 0xffff0000, v67
v_pk_mul_f32 v[88:89], v[72:73], v[8:9]
v_pk_fma_f32 v[88:89], v[74:75], v[10:11], v[88:89]
v_pk_fma_f32 v[88:89], v[76:77], v[12:13], v[88:89]
v_pk_fma_f32 v[88:89], v[78:79], v[14:15], v[88:89]
v_add_f32 v108, v88, v89
s_waitcnt vmcnt(6)
v_accvgpr_read_b32 v68, a52
v_accvgpr_read_b32 v69, a53
v_accvgpr_read_b32 v70, a54
v_accvgpr_read_b32 v71, a55
v_lshlrev_b32 v80, 16, v68
v_and_b32 v81, 0xffff0000, v68
v_lshlrev_b32 v82, 16, v69
v_and_b32 v83, 0xffff0000, v69
v_lshlrev_b32 v84, 16, v70
v_and_b32 v85, 0xffff0000, v70
v_lshlrev_b32 v86, 16, v71
v_and_b32 v87, 0xffff0000, v71
v_pk_mul_f32 v[90:91], v[80:81], v[8:9]
v_pk_fma_f32 v[90:91], v[82:83], v[10:11], v[90:91]
v_pk_fma_f32 v[90:91], v[84:85], v[12:13], v[90:91]
v_pk_fma_f32 v[90:91], v[86:87], v[14:15], v[90:91]
v_add_f32 v109, v90, v91
s_waitcnt vmcnt(5)
v_accvgpr_read_b32 v64, a56
v_accvgpr_read_b32 v65, a57
v_accvgpr_read_b32 v66, a58
v_accvgpr_read_b32 v67, a59
v_lshlrev_b32 v72, 16, v64
v_and_b32 v73, 0xffff0000, v64
v_lshlrev_b32 v74, 16, v65
v_and_b32 v75, 0xffff0000, v65
v_lshlrev_b32 v76, 16, v66
v_and_b32 v77, 0xffff0000, v66
v_lshlrev_b32 v78, 16, v67
v_and_b32 v79, 0xffff0000, v67
v_pk_mul_f32 v[88:89], v[72:73], v[8:9]
v_pk_fma_f32 v[88:89], v[74:75], v[10:11], v[88:89]
v_pk_fma_f32 v[88:89], v[76:77], v[12:13], v[88:89]
v_pk_fma_f32 v[88:89], v[78:79], v[14:15], v[88:89]
v_add_f32 v110, v88, v89
s_waitcnt vmcnt(4)
v_accvgpr_read_b32 v68, a60
v_accvgpr_read_b32 v69, a61
v_accvgpr_read_b32 v70, a62
v_accvgpr_read_b32 v71, a63
v_lshlrev_b32 v80, 16, v68
v_and_b32 v81, 0xffff0000, v68
v_lshlrev_b32 v82, 16, v69
v_and_b32 v83, 0xffff0000, v69
v_lshlrev_b32 v84, 16, v70
v_and_b32 v85, 0xffff0000, v70
v_lshlrev_b32 v86, 16, v71
v_and_b32 v87, 0xffff0000, v71
v_pk_mul_f32 v[90:91], v[80:81], v[8:9]
v_pk_fma_f32 v[90:91], v[82:83], v[10:11], v[90:91]
v_pk_fma_f32 v[90:91], v[84:85], v[12:13], v[90:91]
v_pk_fma_f32 v[90:91], v[86:87], v[14:15], v[90:91]
v_add_f32 v111, v90, v91
v_add_f32_dpp v96, v96, v96 row_shr:1 row_mask:0xf bank_mask:0xf
v_add_f32_dpp v97, v97, v97 row_shr:1 row_mask:0xf bank_mask:0xf
v_add_f32_dpp v98, v98, v98 row_shr:1 row_mask:0xf bank_mask:0xf
v_add_f32_dpp v99, v99, v99 row_shr:1 row_mask:0xf bank_mask:0xf
v_add_f32_dpp v100, v100, v100 row_shr:1 row_mask:0xf bank_mask:0xf
v_add_f32_dpp v101, v101, v101 row_shr:1 row_mask:0xf bank_mask:0xf
v_add_f32_dpp v102, v102, v102 row_shr:1 row_mask:0xf bank_mask:0xf
v_add_f32_dpp v103, v103, v103 row_shr:1 row_mask:0xf bank_mask:0xf
v_add_f32_dpp v104, v104, v104 row_shr:1 row_mask:0xf bank_mask:0xf
v_add_f32_dpp v105, v105, v105 row_shr:1 row_mask:0xf bank_mask:0xf
v_add_f32_dpp v106, v106, v106 row_shr:1 row_mask:0xf bank_mask:0xf
v_add_f32_dpp v107, v107, v107 row_shr:1 row_mask:0xf bank_mask:0xf
v_add_f32_dpp v108, v108, v108 row_shr:1 row_mask:0xf bank_mask:0xf
v_add_f32_dpp v109, v109, v109 row_shr:1 row_mask:0xf bank_mask:0xf
v_add_f32_dpp v110, v110, v110 row_shr:1 row_mask:0xf bank_mask:0xf
v_add_f32_dpp v111, v111, v111 row_shr:1 row_mask:0xf bank_mask:0xf
v_add_f32_dpp v96, v96, v96 row_shr:2 row_mask:0xf bank_mask:0xf
v_add_f32_dpp v97, v97, v97 row_shr:2 row_mask:0xf bank_mask:0xf
v_add_f32_dpp v98, v98, v98 row_shr:2 row_mask:0xf bank_mask:0xf
v_add_f32_dpp v99, v99, v99 row_shr:2 row_mask:0xf bank_mask:0xf
v_add_f32_dpp v100, v100, v100 row_shr:2 row_mask:0xf bank_mask:0xf
v_add_f32_dpp v101, v101, v101 row_shr:2 row_mask:0xf bank_mask:0xf
v_add_f32_dpp v102, v102, v102 row_shr:2 row_mask:0xf bank_mask:0xf
v_add_f32_dpp v103, v103, v103 row_shr:2 row_mask:0xf bank_mask:0xf
v_add_f32_dpp v104, v104, v104 row_shr:2 row_mask:0xf bank_mask:0xf
v_add_f32_dpp v105, v105, v105 row_shr:2 row_mask:0xf bank_mask:0xf
v_add_f32_dpp v106, v106, v106 row_shr:2 row_mask:0xf bank_mask:0xf
v_add_f32_dpp v107, v107, v107 row_shr:2 row_mask:0xf bank_mask:0xf
v_add_f32_dpp v108, v108, v108 row_shr:2 row_mask:0xf bank_mask:0xf
v_add_f32_dpp v109, v109, v109 row_shr:2 row_mask:0xf bank_mask:0xf
v_add_f32_dpp v110, v110, v110 row_shr:2 row_mask:0xf bank_mask:0xf
v_add_f32_dpp v111, v111, v111 row_shr:2 row_mask:0xf bank_mask:0xf
v_add_f32_dpp v96, v96, v96 row_shr:4 row_mask:0xf bank_mask:0xf
v_add_f32_dpp v97, v97, v97 row_shr:4 row_mask:0xf bank_mask:0xf
v_add_f32_dpp v98, v98, v98 row_shr:4 row_mask:0xf bank_mask:0xf
v_add_f32_dpp v99, v99, v99 row_shr:4 row_mask:0xf bank_mask:0xf
v_add_f32_dpp v100, v100, v100 row_shr:4 row_mask:0xf bank_mask:0xf
v_add_f32_dpp v101, v101, v101 row_shr:4 row_mask:0xf bank_mask:0xf
v_add_f32_dpp v102, v102, v102 row_shr:4 row_mask:0xf bank_mask:0xf
v_add_f32_dpp v103, v103, v103 row_shr:4 row_mask:0xf bank_mask:0xf
v_add_f32_dpp v104, v104, v104 row_shr:4 row_mask:0xf bank_mask:0xf
v_add_f32_dpp v105, v105, v105 row_shr:4 row_mask:0xf bank_mask:0xf
v_add_f32_dpp v106, v106, v106 row_shr:4 row_mask:0xf bank_mask:0xf
v_add_f32_dpp v107, v107, v107 row_shr:4 row_mask:0xf bank_mask:0xf
v_add_f32_dpp v108, v108, v108 row_shr:4 row_mask:0xf bank_mask:0xf
v_add_f32_dpp v109, v109, v109 row_shr:4 row_mask:0xf bank_mask:0xf
v_add_f32_dpp v110, v110, v110 row_shr:4 row_mask:0xf bank_mask:0xf
v_add_f32_dpp v111, v111, v111 row_shr:4 row_mask:0xf bank_mask:0xf
v_add_f32_dpp v96, v96, v96 row_shr:8 row_mask:0xf bank_mask:0xf
v_add_f32_dpp v97, v97, v97 row_shr:8 row_mask:0xf bank_mask:0xf
v_add_f32_dpp v98, v98, v98 row_shr:8 row_mask:0xf bank_mask:0xf
v_add_f32_dpp v99, v99, v99 row_shr:8 row_mask:0xf bank_mask:0xf
v_add_f32_dpp v100, v100, v100 row_shr:8 row_mask:0xf bank_mask:0xf
v_add_f32_dpp v101, v101, v101 row_shr:8 row_mask:0xf bank_mask:0xf
v_add_f32_dpp v102, v102, v102 row_shr:8 row_mask:0xf bank_mask:0xf
v_add_f32_dpp v103, v103, v103 row_shr:8 row_mask:0xf bank_mask:0xf
v_add_f32_dpp v104, v104, v104 row_shr:8 row_mask:0xf bank_mask:0xf
v_add_f32_dpp v105, v105, v105 row_shr:8 row_mask:0xf bank_mask:0xf
v_add_f32_dpp v106, v106, v106 row_shr:8 row_mask:0xf bank_mask:0xf
v_add_f32_dpp v107, v107, v107 row_shr:8 row_mask:0xf bank_mask:0xf
v_add_f32_dpp v108, v108, v108 row_shr:8 row_mask:0xf bank_mask:0xf
v_add_f32_dpp v109, v109, v109 row_shr:8 row_mask:0xf bank_mask:0xf
v_add_f32_dpp v110, v110, v110 row_shr:8 row_mask:0xf bank_mask:0xf
v_add_f32_dpp v111, v111, v111 row_shr:8 row_mask:0xf bank_mask:0xf
v_add_f32_dpp v96, v96, v96 row_bcast:15 row_mask:0xa bank_mask:0xf
v_add_f32_dpp v97, v97, v97 row_bcast:15 row_mask:0xa bank_mask:0xf
v_add_f32_dpp v98, v98, v98 row_bcast:15 row_mask:0xa bank_mask:0xf
v_add_f32_dpp v99, v99, v99 row_bcast:15 row_mask:0xa bank_mask:0xf
v_add_f32_dpp v100, v100, v100 row_bcast:15 row_mask:0xa bank_mask:0xf
v_add_f32_dpp v101, v101, v101 row_bcast:15 row_mask:0xa bank_mask:0xf
v_add_f32_dpp v102, v102, v102 row_bcast:15 row_mask:0xa bank_mask:0xf
v_add_f32_dpp v103, v103, v103 row_bcast:15 row_mask:0xa bank_mask:0xf
v_add_f32_dpp v104, v104, v104 row_bcast:15 row_mask:0xa bank_mask:0xf
v_add_f32_dpp v105, v105, v105 row_bcast:15 row_mask:0xa bank_mask:0xf
v_add_f32_dpp v106, v106, v106 row_bcast:15 row_mask:0xa bank_mask:0xf
v_add_f32_dpp v107, v107, v107 row_bcast:15 row_mask:0xa bank_mask:0xf
v_add_f32_dpp v108, v108, v108 row_bcast:15 row_mask:0xa bank_mask:0xf
v_add_f32_dpp v109, v109, v109 row_bcast:15 row_mask:0xa bank_mask:0xf
v_add_f32_dpp v110, v110, v110 row_bcast:15 row_mask:0xa bank_mask:0xf
v_add_f32_dpp v111, v111, v111 row_bcast:15 row_mask:0xa bank_mask:0xf
v_add_f32_dpp v96, v96, v96 row_bcast:31 row_mask:0xc bank_mask:0xf
v_add_f32_dpp v97, v97, v97 row_bcast:31 row_mask:0xc bank_mask:0xf
v_add_f32_dpp v98, v98, v98 row_bcast:31 row_mask:0xc bank_mask:0xf
v_add_f32_dpp v99, v99, v99 row_bcast:31 row_mask:0xc bank_mask:0xf
v_add_f32_dpp v100, v100, v100 row_bcast:31 row_mask:0xc bank_mask:0xf
v_add_f32_dpp v101, v101, v101 row_bcast:31 row_mask:0xc bank_mask:0xf
v_add_f32_dpp v102, v102, v102 row_bcast:31 row_mask:0xc bank_mask:0xf
v_add_f32_dpp v103, v103, v103 row_bcast:31 row_mask:0xc bank_mask:0xf
v_add_f32_dpp v104, v104, v104 row_bcast:31 row_mask:0xc bank_mask:0xf
v_add_f32_dpp v105, v105, v105 row_bcast:31 row_mask:0xc bank_mask:0xf
v_add_f32_dpp v106, v106, v106 row_bcast:31 row_mask:0xc bank_mask:0xf
v_add_f32_dpp v107, v107, v107 row_bcast:31 row_mask:0xc bank_mask:0xf
v_add_f32_dpp v108, v108, v108 row_bcast:31 row_mask:0xc bank_mask:0xf
v_add_f32_dpp v109, v109, v109 row_bcast:31 row_mask:0xc bank_mask:0xf
v_add_f32_dpp v110, v110, v110 row_bcast:31 row_mask:0xc bank_mask:0xf
v_add_f32_dpp v111, v111, v111 row_bcast:31 row_mask:0xc bank_mask:0xf
v_mov_b32 v2, 0
v_readlane_b32 s76, v96, 63
v_readlane_b32 s77, v97, 63
v_readlane_b32 s78, v98, 63
v_readlane_b32 s79, v99, 63
s_nop 0
v_writelane_b32 v2, s76, 0
v_writelane_b32 v2, s77, 1
v_writelane_b32 v2, s78, 2
v_writelane_b32 v2, s79, 3
v_readlane_b32 s76, v100, 63
v_readlane_b32 s77, v101, 63
v_readlane_b32 s78, v102, 63
v_readlane_b32 s79, v103, 63
s_nop 0
v_writelane_b32 v2, s76, 4
v_writelane_b32 v2, s77, 5
v_writelane_b32 v2, s78, 6
v_writelane_b32 v2, s79, 7
v_readlane_b32 s76, v104, 63
v_readlane_b32 s77, v105, 63
v_readlane_b32 s78, v106, 63
v_readlane_b32 s79, v107, 63
s_nop 0
v_writelane_b32 v2, s76, 8
v_writelane_b32 v2, s77, 9
v_writelane_b32 v2, s78, 10
v_writelane_b32 v2, s79, 11
v_readlane_b32 s76, v108, 63
v_readlane_b32 s77, v109, 63
v_readlane_b32 s78, v110, 63
v_readlane_b32 s79, v111, 63
s_nop 0
v_writelane_b32 v2, s76, 12
v_writelane_b32 v2, s77, 13
v_writelane_b32 v2, s78, 14
v_writelane_b32 v2, s79, 15
v_mul_f32 v2, 0xbfb8aa3b, v2
v_exp_f32 v2, v2
s_nop 0
v_add_f32 v2, 1.0, v2
v_rcp_f32 v2, v2
v_and_b32 v1, 63, v0
v_lshlrev_b32 v4, 3, v1
v_mov_b32 v3, s3
s_lshl_b32 s6, s5, 3
s_add_u32 s6, s6, 131072
v_cmp_gt_u32 vcc, 16, v1
s_and_saveexec_b64 s[74:75], vcc
buffer_store_dwordx2 v[2:3], v4, s[36:39], s6 offen sc1
s_mov_b64 exec, s[74:75]
s_waitcnt vmcnt(1)
v_add_u32 v52, 16, v46
v_add_u32 v53, 35088, v46
ds_write_b128 v52, v[30:33] offset:0
ds_write_b128 v52, v[32:35] offset:17536
v_mov_b32 v128, v31
v_mov_b32 v129, v32
v_mov_b32 v130, v33
v_mov_b32 v131, v34
v_mov_b32 v132, v35
v_mov_b32 v133, v36
ds_write_b128 v52, v[128:131] offset:8768
ds_write_b128 v52, v[130:133] offset:26288
v_alignbyte_b32 v134, v31, v30, 2
v_alignbyte_b32 v135, v32, v31, 2
v_alignbyte_b32 v136, v33, v32, 2
v_alignbyte_b32 v137, v34, v33, 2
v_alignbyte_b32 v138, v35, v34, 2
v_alignbyte_b32 v139, v36, v35, 2
ds_write_b128 v52, v[134:137] offset:4368
ds_write_b128 v52, v[136:139] offset:21888
v_alignbyte_b32 v140, v32, v31, 2
v_alignbyte_b32 v141, v33, v32, 2
v_alignbyte_b32 v142, v34, v33, 2
v_alignbyte_b32 v143, v35, v34, 2
v_alignbyte_b32 v144, v36, v35, 2
v_alignbyte_b32 v145, v37, v36, 2
ds_write_b128 v52, v[140:143] offset:13136
ds_write_b128 v52, v[142:145] offset:30656
ds_write_b128 v53, v[38:41] offset:0
ds_write_b128 v53, v[40:43] offset:17536
v_mov_b32 v224, v39
v_mov_b32 v225, v40
v_mov_b32 v226, v41
v_mov_b32 v227, v42
v_mov_b32 v228, v43
v_mov_b32 v229, v44
ds_write_b128 v53, v[224:227] offset:8768
ds_write_b128 v53, v[226:229] offset:26288
v_alignbyte_b32 v230, v39, v38, 2
v_alignbyte_b32 v231, v40, v39, 2
v_alignbyte_b32 v232, v41, v40, 2
v_alignbyte_b32 v233, v42, v41, 2
v_alignbyte_b32 v234, v43, v42, 2
v_alignbyte_b32 v235, v44, v43, 2
ds_write_b128 v53, v[230:233] offset:4368
ds_write_b128 v53, v[232:235] offset:21888
v_alignbyte_b32 v236, v40, v39, 2
v_alignbyte_b32 v237, v41, v40, 2
v_alignbyte_b32 v238, v42, v41, 2
v_alignbyte_b32 v239, v43, v42, 2
v_alignbyte_b32 v240, v44, v43, 2
v_alignbyte_b32 v241, v45, v44, 2
ds_write_b128 v53, v[236:239] offset:13136
ds_write_b128 v53, v[238:241] offset:30656
s_mov_b32 s76, 255
v_cmp_eq_u32 vcc, s76, v0
s_and_saveexec_b64 s[74:75], vcc
ds_write_b128 v52, v[34:37] offset:16
ds_write_b128 v53, v[42:45] offset:16
s_mov_b64 exec, s[74:75]
s_mov_b32 s76, 3414709264
v_lshlrev_b32 v54, 2, v0
v_bfe_u32 v54, s76, v54, 4
v_lshlrev_b32 v54, 4, v54
v_mul_u32_u24 v55, 4352, v0
v_add_u32 v54, v54, v55
v_add_u32 v54, 0, v54
v_cmp_gt_u32 vcc, 8, v0
s_and_saveexec_b64 s[74:75], vcc
ds_write_b128 v54, v[48:51]
ds_write_b128 v54, v[48:51] offset:35072
s_mov_b64 exec, s[74:75]
v_and_b32 v10, 63, v0
v_and_b32 v11, 15, v10
v_lshrrev_b32 v12, 4, v10
v_add_u32 v13, 1, v11
v_and_b32 v14, 7, v13
v_lshrrev_b32 v15, 3, v13
s_mov_b32 s74, 3414709264
v_lshlrev_b32 v16, 2, v14
v_bfe_u32 v16, s74, v16, 4
v_add_u32 v16, v16, v15
v_add_u32 v16, v16, v12
v_lshlrev_b32 v16, 4, v16
v_mul_u32_u24 v17, 4352, v14
v_add_u32 v16, v16, v17
s_lshr_b32 s75, s4, 1
s_mul_i32 s76, s75, 35072
s_and_b32 s77, s4, 1
s_lshl_b32 s77, s77, 8
s_add_u32 s76, s76, s77
s_add_u32 s76, s76, 0
v_add_u32 v59, s76, v16
s_mul_i32 s76, s75, 4608
s_add_u32 s76, s76, s77
s_add_u32 s76, s76, 139744
v_lshlrev_b32 v16, 5, v11
v_lshlrev_b32 v17, 4, v12
v_sub_u32 v16, v17, v16
v_add_u32 v60, s76, v16
s_mov_b32 s94, 0
buffer_load_dword v62, v56, s[36:39], s94 offen sc1
s_waitcnt vmcnt(0)
s_cmp_eq_u32 s4, 0
s_cbranch_scc0 POK_8
v_cmp_ne_u32 vcc, s3, v62
s_cbranch_vccz POK_8
s_mov_b32 s97, 0
s_mov_b32 s101, 32768
PRT_9:
s_sleep 1
buffer_load_dword v62, v56, s[36:39], s97 offen sc1
s_waitcnt vmcnt(0)
v_cmp_ne_u32 vcc, s3, v62
s_cbranch_vccz POK_8
s_sub_u32 s101, s101, 1
s_cbranch_scc0 PRT_9
POK_8:
s_barrier
s_lshl_b32 s94, s2, 13
s_add_u32 s94, s94, 1048576
buffer_load_dwordx4 v[244:247], v46, s[36:39], s94 offen sc1
s_lshl_b32 s94, s2, 13
s_add_u32 s94, s94, 1052672
buffer_load_dwordx4 v[248:251], v46, s[36:39], s94 offen sc1
s_lshr_b32 s92, s2, 5
s_lshl_b32 s92, s92, 7
s_mul_i32 s93, s4, 28
s_add_u32 s92, s92, s93
s_lshl_b32 s92, s92, 11
s_add_u32 s92, s92, 3145728
s_and_b32 s93, s4, 1
s_lshl_b32 s93, s93, 10
s_add_u32 s92, s92, s93
s_xor_b32 s93, s92, 1024
buffer_load_dwordx4 a[0:3], v58, s[36:39], s92 offen offset:0 sc1
buffer_load_dwordx4 a[4:7], v58, s[36:39], s93 offen offset:0 sc1
buffer_load_dwordx4 a[8:11], v58, s[36:39], s92 offen offset:2048 sc1
buffer_load_dwordx4 a[12:15], v58, s[36:39], s93 offen offset:2048 sc1
s_add_u32 s92, s92, 4096
buffer_load_dwordx4 a[16:19], v58, s[36:39], s92 offen offset:0 sc1
s_add_u32 s93, s93, 4096
buffer_load_dwordx4 a[20:23], v58, s[36:39], s93 offen offset:0 sc1
buffer_load_dwordx4 a[24:27], v58, s[36:39], s92 offen offset:2048 sc1
buffer_load_dwordx4 a[28:31], v58, s[36:39], s93 offen offset:2048 sc1
s_add_u32 s92, s92, 4096
buffer_load_dwordx4 a[32:35], v58, s[36:39], s92 offen offset:0 sc1
s_add_u32 s93, s93, 4096
buffer_load_dwordx4 a[36:39], v58, s[36:39], s93 offen offset:0 sc1
buffer_load_dwordx4 a[40:43], v58, s[36:39], s92 offen offset:2048 sc1
buffer_load_dwordx4 a[44:47], v58, s[36:39], s93 offen offset:2048 sc1
s_add_u32 s92, s92, 4096
buffer_load_dwordx4 a[48:51], v58, s[36:39], s92 offen offset:0 sc1
s_add_u32 s93, s93, 4096
buffer_load_dwordx4 a[52:55], v58, s[36:39], s93 offen offset:0 sc1
buffer_load_dwordx4 a[56:59], v58, s[36:39], s92 offen offset:2048 sc1
buffer_load_dwordx4 a[60:63], v58, s[36:39], s93 offen offset:2048 sc1
s_add_u32 s92, s92, 4096
buffer_load_dwordx4 a[64:67], v58, s[36:39], s92 offen offset:0 sc1
s_add_u32 s93, s93, 4096
buffer_load_dwordx4 a[68:71], v58, s[36:39], s93 offen offset:0 sc1
buffer_load_dwordx4 a[72:75], v58, s[36:39], s92 offen offset:2048 sc1
buffer_load_dwordx4 a[76:79], v58, s[36:39], s93 offen offset:2048 sc1
s_add_u32 s92, s92, 4096
buffer_load_dwordx4 a[80:83], v58, s[36:39], s92 offen offset:0 sc1
s_add_u32 s93, s93, 4096
buffer_load_dwordx4 a[84:87], v58, s[36:39], s93 offen offset:0 sc1
buffer_load_dwordx4 a[88:91], v58, s[36:39], s92 offen offset:2048 sc1
buffer_load_dwordx4 a[92:95], v58, s[36:39], s93 offen offset:2048 sc1
s_add_u32 s92, s92, 4096
buffer_load_dwordx4 a[96:99], v58, s[36:39], s92 offen offset:0 sc1
s_add_u32 s93, s93, 4096
buffer_load_dwordx4 a[100:103], v58, s[36:39], s93 offen offset:0 sc1
buffer_load_dwordx4 a[104:107], v58, s[36:39], s92 offen offset:2048 sc1
v_add_u32 v54, 139264, v46
s_waitcnt vmcnt(27)
ds_write_b128 v54, v[244:247] offset:0
ds_write_b128 v54, v[248:251] offset:4608
s_waitcnt vmcnt(0) lgkmcnt(0)
JOIN:
s_waitcnt lgkmcnt(0)
s_barrier
s_and_b32 s5, s2, 7
s_lshl_b32 s5, s5, 2
s_lshr_b32 s6, s2, 3
s_and_b32 s6, s6, 3
s_add_u32 s5, s5, s6
s_lshr_b32 s6, s2, 5
s_lshr_b32 s74, s4, 1
s_lshl_b32 s75, s5, 1
s_add_u32 s80, s75, s74
s_xor_b32 s81, s80, 1
s_mul_i32 s78, s4, 28
s_mul_i32 s80, s80, 112
s_add_u32 s80, s80, s78
s_lshl_b32 s80, s80, 10
s_add_u32 s80, s80, 5242880
s_mul_i32 s81, s81, 112
s_add_u32 s81, s81, s78
s_lshl_b32 s81, s81, 10
s_add_u32 s81, s81, 5242880
ds_read_b128 v[96:99], v59 offset:0
ds_read_b128 v[160:163], v60 offset:3584
ds_read_b128 v[100:103], v59 offset:512
ds_read_b128 v[164:167], v60 offset:3072
ds_read_b128 v[104:107], v59 offset:1024
ds_read_b128 v[168:171], v60 offset:2560
ds_read_b128 v[108:111], v59 offset:1536
ds_read_b128 v[172:175], v60 offset:2048
ds_read_b128 v[112:115], v59 offset:2048
ds_read_b128 v[176:179], v60 offset:1536
ds_read_b128 v[116:119], v59 offset:2560
ds_read_b128 v[180:183], v60 offset:1024
ds_read_b128 v[120:123], v59 offset:3072
ds_read_b128 v[184:187], v60 offset:512
buffer_load_dwordx4 a[108:111], v58, s[36:39], s93 offen offset:2048 sc1
ds_read_b128 v[124:127], v59 offset:3584
ds_read_b128 v[188:191], v60 offset:0
s_waitcnt lgkmcnt(14)
v_mfma_f32_16x16x32_bf16 v[64:67], v[96:99], v[160:163], 0
s_waitcnt lgkmcnt(13)
v_mfma_f32_16x16x32_bf16 v[68:71], v[100:103], v[160:163], 0
s_waitcnt lgkmcnt(12)
v_mfma_f32_16x16x32_bf16 v[72:75], v[100:103], v[164:167], 0
s_add_u32 s92, s92, 4096
buffer_load_dwordx4 a[112:115], v58, s[36:39], s92 offen offset:0 sc1
s_waitcnt lgkmcnt(11)
v_mfma_f32_16x16x32_bf16 v[76:79], v[104:107], v[164:167], 0
v_mfma_f32_16x16x32_bf16 v[68:71], v[96:99], v[164:167], v[68:71]
v_mfma_f32_16x16x32_bf16 v[72:75], v[104:107], v[160:163], v[72:75]
s_add_u32 s93, s93, 4096
buffer_load_dwordx4 a[116:119], v58, s[36:39], s93 offen offset:0 sc1
s_waitcnt lgkmcnt(10)
v_mfma_f32_16x16x32_bf16 v[76:79], v[100:103], v[168:171], v[76:79]
v_mfma_f32_16x16x32_bf16 v[80:83], v[104:107], v[168:171], 0
v_mfma_f32_16x16x32_bf16 v[72:75], v[96:99], v[168:171], v[72:75]
buffer_load_dwordx4 a[120:123], v58, s[36:39], s92 offen offset:2048 sc1
s_waitcnt lgkmcnt(9)
v_mfma_f32_16x16x32_bf16 v[76:79], v[108:111], v[160:163], v[76:79]
v_mfma_f32_16x16x32_bf16 v[80:83], v[108:111], v[164:167], v[80:83]
v_mfma_f32_16x16x32_bf16 v[84:87], v[108:111], v[168:171], 0
buffer_load_dwordx4 a[124:127], v58, s[36:39], s93 offen offset:2048 sc1
s_waitcnt lgkmcnt(8)
v_mfma_f32_16x16x32_bf16 v[76:79], v[96:99], v[172:175], v[76:79]
v_mfma_f32_16x16x32_bf16 v[80:83], v[100:103], v[172:175], v[80:83]
v_mfma_f32_16x16x32_bf16 v[84:87], v[104:107], v[172:175], v[84:87]
s_add_u32 s92, s92, 4096
buffer_load_dwordx4 a[128:131], v58, s[36:39], s92 offen offset:0 sc1
v_mfma_f32_16x16x32_bf16 v[88:91], v[108:111], v[172:175], 0
s_waitcnt lgkmcnt(7)
v_mfma_f32_16x16x32_bf16 v[80:83], v[112:115], v[160:163], v[80:83]
v_mfma_f32_16x16x32_bf16 v[84:87], v[112:115], v[164:167], v[84:87]
v_mfma_f32_16x16x32_bf16 v[88:91], v[112:115], v[168:171], v[88:91]
s_add_u32 s93, s93, 4096
buffer_load_dwordx4 a[132:135], v58, s[36:39], s93 offen offset:0 sc1
ds_read_b128 v[128:131], v59 offset:64
s_waitcnt lgkmcnt(7)
v_mfma_f32_16x16x32_bf16 v[80:83], v[96:99], v[176:179], v[80:83]
ds_read_b128 v[192:195], v60 offset:3648
v_mfma_f32_16x16x32_bf16 v[84:87], v[100:103], v[176:179], v[84:87]
ds_read_b128 v[132:135], v59 offset:576
v_mfma_f32_16x16x32_bf16 v[88:91], v[104:107], v[176:179], v[88:91]
buffer_load_dwordx4 a[136:139], v58, s[36:39], s92 offen offset:2048 sc1
ds_read_b128 v[196:199], v60 offset:3136
v_mfma_f32_16x16x32_bf16 v[92:95], v[112:115], v[172:175], 0
ds_read_b128 v[136:139], v59 offset:1088
s_waitcnt lgkmcnt(10)
v_mfma_f32_16x16x32_bf16 v[84:87], v[116:119], v[160:163], v[84:87]
ds_read_b128 v[200:203], v60 offset:2624
v_mfma_f32_16x16x32_bf16 v[88:91], v[116:119], v[164:167], v[88:91]
buffer_load_dwordx4 a[140:143], v58, s[36:39], s93 offen offset:2048 sc1
ds_read_b128 v[140:143], v59 offset:1600
v_mfma_f32_16x16x32_bf16 v[92:95], v[108:111], v[176:179], v[92:95]
ds_read_b128 v[204:207], v60 offset:2112
s_waitcnt lgkmcnt(12)
v_mfma_f32_16x16x32_bf16 v[84:87], v[96:99], v[180:183], v[84:87]
ds_read_b128 v[144:147], v59 offset:2112
v_mfma_f32_16x16x32_bf16 v[88:91], v[100:103], v[180:183], v[88:91]
s_add_u32 s92, s92, 4096
buffer_load_dwordx4 a[144:147], v58, s[36:39], s92 offen offset:0 sc1
ds_read_b128 v[208:211], v60 offset:1600
v_mfma_f32_16x16x32_bf16 v[92:95], v[116:119], v[168:171], v[92:95]
ds_read_b128 v[148:151], v59 offset:2624
v_mfma_f32_16x16x32_bf16 v[92:95], v[104:107], v[180:183], v[92:95]
ds_read_b128 v[212:215], v60 offset:1088
s_waitcnt lgkmcnt(15)
v_mfma_f32_16x16x32_bf16 v[88:91], v[120:123], v[160:163], v[88:91]
s_add_u32 s93, s93, 4096
buffer_load_dwordx4 a[148:151], v58, s[36:39], s93 offen offset:0 sc1
ds_read_b128 v[152:155], v59 offset:3136
s_waitcnt lgkmcnt(15)
v_mfma_f32_16x16x32_bf16 v[88:91], v[96:99], v[184:187], v[88:91]
ds_read_b128 v[216:219], v60 offset:576
v_mfma_f32_16x16x32_bf16 v[92:95], v[120:123], v[164:167], v[92:95]
ds_read_b128 v[156:159], v59 offset:3648
v_mfma_f32_16x16x32_bf16 v[92:95], v[100:103], v[184:187], v[92:95]
buffer_load_dwordx4 a[152:155], v58, s[36:39], s92 offen offset:2048 sc1
ds_read_b128 v[220:223], v60 offset:64
s_waitcnt lgkmcnt(15)
v_mfma_f32_16x16x32_bf16 v[92:95], v[124:127], v[160:163], v[92:95]
v_mfma_f32_16x16x32_bf16 v[92:95], v[96:99], v[188:191], v[92:95]
s_waitcnt lgkmcnt(14)
v_mfma_f32_16x16x32_bf16 v[64:67], v[128:131], v[192:195], v[64:67]
buffer_load_dwordx4 a[156:159], v58, s[36:39], s93 offen offset:2048 sc1
s_waitcnt lgkmcnt(13)
v_mfma_f32_16x16x32_bf16 v[68:71], v[132:135], v[192:195], v[68:71]
s_waitcnt lgkmcnt(12)
v_mfma_f32_16x16x32_bf16 v[72:75], v[132:135], v[196:199], v[72:75]
s_waitcnt lgkmcnt(11)
v_mfma_f32_16x16x32_bf16 v[76:79], v[136:139], v[196:199], v[76:79]
s_add_u32 s92, s92, 4096
buffer_load_dwordx4 a[160:163], v58, s[36:39], s92 offen offset:0 sc1
v_mfma_f32_16x16x32_bf16 v[68:71], v[128:131], v[196:199], v[68:71]
v_mfma_f32_16x16x32_bf16 v[72:75], v[136:139], v[192:195], v[72:75]
s_waitcnt lgkmcnt(10)
v_mfma_f32_16x16x32_bf16 v[76:79], v[132:135], v[200:203], v[76:79]
v_mfma_f32_16x16x32_bf16 v[80:83], v[136:139], v[200:203], v[80:83]
s_add_u32 s93, s93, 4096
buffer_load_dwordx4 a[164:167], v58, s[36:39], s93 offen offset:0 sc1
v_mfma_f32_16x16x32_bf16 v[72:75], v[128:131], v[200:203], v[72:75]
s_waitcnt lgkmcnt(9)
v_mfma_f32_16x16x32_bf16 v[76:79], v[140:143], v[192:195], v[76:79]
v_mfma_f32_16x16x32_bf16 v[80:83], v[140:143], v[196:199], v[80:83]
v_mfma_f32_16x16x32_bf16 v[84:87], v[140:143], v[200:203], v[84:87]
buffer_load_dwordx4 a[168:171], v58, s[36:39], s92 offen offset:2048 sc1
s_waitcnt lgkmcnt(8)
v_mfma_f32_16x16x32_bf16 v[76:79], v[128:131], v[204:207], v[76:79]
v_mfma_f32_16x16x32_bf16 v[80:83], v[132:135], v[204:207], v[80:83]
v_mfma_f32_16x16x32_bf16 v[84:87], v[136:139], v[204:207], v[84:87]
buffer_load_dwordx4 a[172:175], v58, s[36:39], s93 offen offset:2048 sc1
v_mfma_f32_16x16x32_bf16 v[88:91], v[140:143], v[204:207], v[88:91]
s_waitcnt lgkmcnt(7)
v_mfma_f32_16x16x32_bf16 v[80:83], v[144:147], v[192:195], v[80:83]
v_mfma_f32_16x16x32_bf16 v[84:87], v[144:147], v[196:199], v[84:87]
v_mfma_f32_16x16x32_bf16 v[88:91], v[144:147], v[200:203], v[88:91]
s_add_u32 s92, s92, 4096
buffer_load_dwordx4 a[176:179], v58, s[36:39], s92 offen offset:0 sc1
ds_read_b128 v[96:99], v59 offset:128
s_waitcnt vmcnt(18)
s_barrier
s_cmp_eq_u32 s4, 0
s_cbranch_scc0 PUB_10
s_lshl_b32 s97, s2, 7
s_add_u32 s97, s97, 32768
v_mov_b32 v62, s3
s_mov_b64 exec, 1
buffer_store_dword v62, off, s[36:39], s97 sc1
s_mov_b64 exec, -1
PUB_10:
s_add_u32 s93, s93, 4096
buffer_load_dwordx4 a[180:183], v58, s[36:39], s93 offen offset:0 sc1
s_waitcnt lgkmcnt(7)
v_mfma_f32_16x16x32_bf16 v[80:83], v[128:131], v[208:211], v[80:83]
ds_read_b128 v[160:163], v60 offset:3712
v_mfma_f32_16x16x32_bf16 v[84:87], v[132:135], v[208:211], v[84:87]
ds_read_b128 v[100:103], v59 offset:640
v_mfma_f32_16x16x32_bf16 v[88:91], v[136:139], v[208:211], v[88:91]
buffer_load_dwordx4 a[184:187], v58, s[36:39], s92 offen offset:2048 sc1
ds_read_b128 v[164:167], v60 offset:3200
v_mfma_f32_16x16x32_bf16 v[92:95], v[144:147], v[204:207], v[92:95]
ds_read_b128 v[104:107], v59 offset:1152
s_waitcnt lgkmcnt(10)
v_mfma_f32_16x16x32_bf16 v[84:87], v[148:151], v[192:195], v[84:87]
ds_read_b128 v[168:171], v60 offset:2688
v_mfma_f32_16x16x32_bf16 v[88:91], v[148:151], v[196:199], v[88:91]
buffer_load_dwordx4 a[188:191], v58, s[36:39], s93 offen offset:2048 sc1
ds_read_b128 v[108:111], v59 offset:1664
v_mfma_f32_16x16x32_bf16 v[92:95], v[140:143], v[208:211], v[92:95]
ds_read_b128 v[172:175], v60 offset:2176
s_waitcnt lgkmcnt(12)
v_mfma_f32_16x16x32_bf16 v[84:87], v[128:131], v[212:215], v[84:87]
ds_read_b128 v[112:115], v59 offset:2176
v_mfma_f32_16x16x32_bf16 v[88:91], v[132:135], v[212:215], v[88:91]
s_add_u32 s92, s92, 4096
buffer_load_dwordx4 a[192:195], v58, s[36:39], s92 offen offset:0 sc1
ds_read_b128 v[176:179], v60 offset:1664
v_mfma_f32_16x16x32_bf16 v[92:95], v[148:151], v[200:203], v[92:95]
ds_read_b128 v[116:119], v59 offset:2688
v_mfma_f32_16x16x32_bf16 v[92:95], v[136:139], v[212:215], v[92:95]
ds_read_b128 v[180:183], v60 offset:1152
s_waitcnt lgkmcnt(15)
v_mfma_f32_16x16x32_bf16 v[88:91], v[152:155], v[192:195], v[88:91]
s_add_u32 s93, s93, 4096
buffer_load_dwordx4 a[196:199], v58, s[36:39], s93 offen offset:0 sc1
ds_read_b128 v[120:123], v59 offset:3200
s_waitcnt lgkmcnt(15)
v_mfma_f32_16x16x32_bf16 v[88:91], v[128:131], v[216:219], v[88:91]
ds_read_b128 v[184:187], v60 offset:640
v_mfma_f32_16x16x32_bf16 v[92:95], v[152:155], v[196:199], v[92:95]
ds_read_b128 v[124:127], v59 offset:3712
v_mfma_f32_16x16x32_bf16 v[92:95], v[132:135], v[216:219], v[92:95]
buffer_load_dwordx4 a[200:203], v58, s[36:39], s92 offen offset:2048 sc1
ds_read_b128 v[188:191], v60 offset:128
s_waitcnt lgkmcnt(15)
v_mfma_f32_16x16x32_bf16 v[92:95], v[156:159], v[192:195], v[92:95]
v_mfma_f32_16x16x32_bf16 v[92:95], v[128:131], v[220:223], v[92:95]
s_waitcnt lgkmcnt(14)
v_mfma_f32_16x16x32_bf16 v[64:67], v[96:99], v[160:163], v[64:67]
buffer_load_dwordx4 a[204:207], v58, s[36:39], s93 offen offset:2048 sc1
s_waitcnt lgkmcnt(13)
v_mfma_f32_16x16x32_bf16 v[68:71], v[100:103], v[160:163], v[68:71]
s_waitcnt lgkmcnt(12)
v_mfma_f32_16x16x32_bf16 v[72:75], v[100:103], v[164:167], v[72:75]
s_waitcnt lgkmcnt(11)
v_mfma_f32_16x16x32_bf16 v[76:79], v[104:107], v[164:167], v[76:79]
s_add_u32 s92, s92, 4096
buffer_load_dwordx4 a[208:211], v58, s[36:39], s92 offen offset:0 sc1
v_mfma_f32_16x16x32_bf16 v[68:71], v[96:99], v[164:167], v[68:71]
v_mfma_f32_16x16x32_bf16 v[72:75], v[104:107], v[160:163], v[72:75]
s_waitcnt lgkmcnt(10)
v_mfma_f32_16x16x32_bf16 v[76:79], v[100:103], v[168:171], v[76:79]
v_mfma_f32_16x16x32_bf16 v[80:83], v[104:107], v[168:171], v[80:83]
s_add_u32 s93, s93, 4096
buffer_load_dwordx4 a[212:215], v58, s[36:39], s93 offen offset:0 sc1
v_mfma_f32_16x16x32_bf16 v[72:75], v[96:99], v[168:171], v[72:75]
s_waitcnt lgkmcnt(9)
v_mfma_f32_16x16x32_bf16 v[76:79], v[108:111], v[160:163], v[76:79]
v_mfma_f32_16x16x32_bf16 v[80:83], v[108:111], v[164:167], v[80:83]
v_mfma_f32_16x16x32_bf16 v[84:87], v[108:111], v[168:171], v[84:87]
buffer_load_dwordx4 a[216:219], v58, s[36:39], s92 offen offset:2048 sc1
s_waitcnt lgkmcnt(8)
v_mfma_f32_16x16x32_bf16 v[76:79], v[96:99], v[172:175], v[76:79]
v_mfma_f32_16x16x32_bf16 v[80:83], v[100:103], v[172:175], v[80:83]
v_mfma_f32_16x16x32_bf16 v[84:87], v[104:107], v[172:175], v[84:87]
buffer_load_dwordx4 a[220:223], v58, s[36:39], s93 offen offset:2048 sc1
v_mfma_f32_16x16x32_bf16 v[88:91], v[108:111], v[172:175], v[88:91]
s_waitcnt lgkmcnt(7)
v_mfma_f32_16x16x32_bf16 v[80:83], v[112:115], v[160:163], v[80:83]
v_mfma_f32_16x16x32_bf16 v[84:87], v[112:115], v[164:167], v[84:87]
v_mfma_f32_16x16x32_bf16 v[88:91], v[112:115], v[168:171], v[88:91]
ds_read_b128 v[128:131], v59 offset:192
s_waitcnt lgkmcnt(7)
v_mfma_f32_16x16x32_bf16 v[80:83], v[96:99], v[176:179], v[80:83]
ds_read_b128 v[192:195], v60 offset:3776
v_mfma_f32_16x16x32_bf16 v[84:87], v[100:103], v[176:179], v[84:87]
ds_read_b128 v[132:135], v59 offset:704
v_mfma_f32_16x16x32_bf16 v[88:91], v[104:107], v[176:179], v[88:91]
ds_read_b128 v[196:199], v60 offset:3264
v_mfma_f32_16x16x32_bf16 v[92:95], v[112:115], v[172:175], v[92:95]
ds_read_b128 v[136:139], v59 offset:1216
s_waitcnt lgkmcnt(10)
v_mfma_f32_16x16x32_bf16 v[84:87], v[116:119], v[160:163], v[84:87]
ds_read_b128 v[200:203], v60 offset:2752
v_mfma_f32_16x16x32_bf16 v[88:91], v[116:119], v[164:167], v[88:91]
ds_read_b128 v[140:143], v59 offset:1728
v_mfma_f32_16x16x32_bf16 v[92:95], v[108:111], v[176:179], v[92:95]
ds_read_b128 v[204:207], v60 offset:2240
s_waitcnt lgkmcnt(12)
v_mfma_f32_16x16x32_bf16 v[84:87], v[96:99], v[180:183], v[84:87]
ds_read_b128 v[144:147], v59 offset:2240
v_mfma_f32_16x16x32_bf16 v[88:91], v[100:103], v[180:183], v[88:91]
ds_read_b128 v[208:211], v60 offset:1728
v_mfma_f32_16x16x32_bf16 v[92:95], v[116:119], v[168:171], v[92:95]
ds_read_b128 v[148:151], v59 offset:2752
s_mov_b32 s94, 32768
buffer_load_dword v62, v57, s[36:39], s94 offen sc1
v_mfma_f32_16x16x32_bf16 v[92:95], v[104:107], v[180:183], v[92:95]
ds_read_b128 v[212:215], v60 offset:1216
s_waitcnt lgkmcnt(15)
v_mfma_f32_16x16x32_bf16 v[88:91], v[120:123], v[160:163], v[88:91]
ds_read_b128 v[152:155], v59 offset:3264
s_waitcnt lgkmcnt(15)
v_mfma_f32_16x16x32_bf16 v[88:91], v[96:99], v[184:187], v[88:91]
ds_read_b128 v[216:219], v60 offset:704
v_mfma_f32_16x16x32_bf16 v[92:95], v[120:123], v[164:167], v[92:95]
ds_read_b128 v[156:159], v59 offset:3776
v_mfma_f32_16x16x32_bf16 v[92:95], v[100:103], v[184:187], v[92:95]
ds_read_b128 v[220:223], v60 offset:192
s_waitcnt lgkmcnt(15)
v_mfma_f32_16x16x32_bf16 v[92:95], v[124:127], v[160:163], v[92:95]
v_mfma_f32_16x16x32_bf16 v[92:95], v[96:99], v[188:191], v[92:95]
s_waitcnt lgkmcnt(14)
v_mfma_f32_16x16x32_bf16 v[64:67], v[128:131], v[192:195], v[64:67]
s_waitcnt lgkmcnt(13)
v_mfma_f32_16x16x32_bf16 v[68:71], v[132:135], v[192:195], v[68:71]
s_waitcnt lgkmcnt(12)
v_mfma_f32_16x16x32_bf16 v[72:75], v[132:135], v[196:199], v[72:75]
s_waitcnt lgkmcnt(11)
v_mfma_f32_16x16x32_bf16 v[76:79], v[136:139], v[196:199], v[76:79]
v_mfma_f32_16x16x32_bf16 v[68:71], v[128:131], v[196:199], v[68:71]
v_mfma_f32_16x16x32_bf16 v[72:75], v[136:139], v[192:195], v[72:75]
s_waitcnt lgkmcnt(10)
v_mfma_f32_16x16x32_bf16 v[76:79], v[132:135], v[200:203], v[76:79]
v_mfma_f32_16x16x32_bf16 v[80:83], v[136:139], v[200:203], v[80:83]
v_mfma_f32_16x16x32_bf16 v[72:75], v[128:131], v[200:203], v[72:75]
s_waitcnt lgkmcnt(9)
v_mfma_f32_16x16x32_bf16 v[76:79], v[140:143], v[192:195], v[76:79]
v_mfma_f32_16x16x32_bf16 v[80:83], v[140:143], v[196:199], v[80:83]
v_mfma_f32_16x16x32_bf16 v[84:87], v[140:143], v[200:203], v[84:87]
s_waitcnt lgkmcnt(8)
v_mfma_f32_16x16x32_bf16 v[76:79], v[128:131], v[204:207], v[76:79]
v_mfma_f32_16x16x32_bf16 v[80:83], v[132:135], v[204:207], v[80:83]
v_mfma_f32_16x16x32_bf16 v[84:87], v[136:139], v[204:207], v[84:87]
v_mfma_f32_16x16x32_bf16 v[88:91], v[140:143], v[204:207], v[88:91]
s_waitcnt lgkmcnt(7)
v_mfma_f32_16x16x32_bf16 v[80:83], v[144:147], v[192:195], v[80:83]
v_mfma_f32_16x16x32_bf16 v[84:87], v[144:147], v[196:199], v[84:87]
v_mfma_f32_16x16x32_bf16 v[88:91], v[144:147], v[200:203], v[88:91]
s_waitcnt lgkmcnt(6)
v_mfma_f32_16x16x32_bf16 v[80:83], v[128:131], v[208:211], v[80:83]
v_mfma_f32_16x16x32_bf16 v[84:87], v[132:135], v[208:211], v[84:87]
v_mfma_f32_16x16x32_bf16 v[88:91], v[136:139], v[208:211], v[88:91]
v_mfma_f32_16x16x32_bf16 v[92:95], v[144:147], v[204:207], v[92:95]
s_waitcnt lgkmcnt(5)
v_mfma_f32_16x16x32_bf16 v[84:87], v[148:151], v[192:195], v[84:87]
v_mfma_f32_16x16x32_bf16 v[88:91], v[148:151], v[196:199], v[88:91]
v_mfma_f32_16x16x32_bf16 v[92:95], v[140:143], v[208:211], v[92:95]
s_waitcnt lgkmcnt(4)
v_mfma_f32_16x16x32_bf16 v[84:87], v[128:131], v[212:215], v[84:87]
v_mfma_f32_16x16x32_bf16 v[88:91], v[132:135], v[212:215], v[88:91]
v_mfma_f32_16x16x32_bf16 v[92:95], v[148:151], v[200:203], v[92:95]
v_mfma_f32_16x16x32_bf16 v[92:95], v[136:139], v[212:215], v[92:95]
s_waitcnt lgkmcnt(3)
v_mfma_f32_16x16x32_bf16 v[88:91], v[152:155], v[192:195], v[88:91]
s_waitcnt lgkmcnt(2)
v_mfma_f32_16x16x32_bf16 v[88:91], v[128:131], v[216:219], v[88:91]
v_mfma_f32_16x16x32_bf16 v[92:95], v[152:155], v[196:199], v[92:95]
v_mfma_f32_16x16x32_bf16 v[92:95], v[132:135], v[216:219], v[92:95]
s_waitcnt lgkmcnt(1)
v_mfma_f32_16x16x32_bf16 v[92:95], v[156:159], v[192:195], v[92:95]
s_waitcnt lgkmcnt(0)
v_mfma_f32_16x16x32_bf16 v[92:95], v[128:131], v[220:223], v[92:95]
v_and_b32 v10, 63, v0
v_and_b32 v11, 15, v10
v_lshrrev_b32 v12, 4, v10
v_lshlrev_b32 v11, 6, v11
v_lshl_add_u32 v11, v12, 4, v11
s_lshl_b32 s74, s4, 13
s_add_u32 s74, s74, 98304
v_add_u32 v11, s74, v11
s_lshr_b32 s75, s4, 1
ds_write_b128 v11, v[64:67] offset:0
ds_write_b128 v11, v[68:71] offset:1024
ds_write_b128 v11, v[72:75] offset:2048
ds_write_b128 v11, v[76:79] offset:3072
ds_write_b128 v11, v[80:83] offset:4096
ds_write_b128 v11, v[84:87] offset:5120
ds_write_b128 v11, v[88:91] offset:6144
ds_write_b128 v11, v[92:95] offset:7168
v_and_b32 v1, 127, v0
v_lshlrev_b32 v2, 5, v1
s_lshl_b32 s74, s75, 14
s_add_u32 s74, s74, 98304
v_add_u32 v2, s74, v2
s_mul_i32 s74, s75, 4608
s_add_u32 s74, s74, 141296
v_lshlrev_b32 v3, 4, v1
v_sub_u32 v3, s74, v3
s_lshl_b32 s79, s75, 4
s_lshr_b32 s77, s23, s79
s_lshl_b32 s77, s77, 16
s_waitcnt lgkmcnt(0)
s_waitcnt vmcnt(0)
s_cmp_eq_u32 s4, 0
s_cbranch_scc0 POK_11
v_cmp_ne_u32 vcc, s3, v62
s_cbranch_vccz POK_11
s_mov_b32 s97, 32768
s_mov_b32 s101, 32768
PRT_12:
s_sleep 1
buffer_load_dword v62, v57, s[36:39], s97 offen sc1
s_waitcnt vmcnt(0)
v_cmp_ne_u32 vcc, s3, v62
s_cbranch_vccz POK_11
s_sub_u32 s101, s101, 1
s_cbranch_scc0 PRT_12
POK_11:
s_barrier
ds_read_b128 v[8:11], v2 offset:0
buffer_load_dwordx4 v[128:131], v58, s[36:39], s80 offen offset:0 sc1
ds_read_b128 v[12:15], v2 offset:16
ds_read_b128 v[16:19], v2 offset:8192
ds_read_b128 v[20:23], v2 offset:8208
ds_read_b128 v[24:27], v3 offset:2048
ds_read_b128 v[32:35], v2 offset:4096
ds_read_b128 v[36:39], v2 offset:4112
ds_read_b128 v[40:43], v2 offset:12288
buffer_load_dwordx4 v[132:135], v58, s[36:39], s81 offen offset:0 sc1
ds_read_b128 v[44:47], v2 offset:12304
ds_read_b128 v[48:51], v3 offset:0
s_lshl_b32 s74, s2, 14
s_lshl_b32 s79, s75, 13
s_add_u32 s74, s74, s79
s_add_u32 s74, s74, 25165824
s_add_u32 s79, s74, 4096
buffer_load_dwordx4 v[136:139], v58, s[36:39], s80 offen offset:1024 sc1
v_lshlrev_b32 v4, 4, v1
s_waitcnt lgkmcnt(5)
v_pk_add_f32 v[8:9], v[8:9], v[16:17]
v_pk_add_f32 v[10:11], v[10:11], v[18:19]
v_pk_add_f32 v[12:13], v[12:13], v[20:21]
v_pk_add_f32 v[14:15], v[14:15], v[22:23]
v_and_b32 v6, 0xffff0000, v27
buffer_load_dwordx4 v[140:143], v58, s[36:39], s81 offen offset:1024 sc1
v_fmac_f32 v8, s77, v6
v_lshlrev_b32 v7, 16, v27
v_fmac_f32 v9, s77, v7
v_and_b32 v6, 0xffff0000, v26
v_fmac_f32 v10, s77, v6
v_lshlrev_b32 v7, 16, v26
v_fmac_f32 v11, s77, v7
buffer_load_dwordx4 v[144:147], v58, s[36:39], s80 offen offset:2048 sc1
v_and_b32 v6, 0xffff0000, v25
v_fmac_f32 v12, s77, v6
v_lshlrev_b32 v7, 16, v25
v_fmac_f32 v13, s77, v7
v_and_b32 v6, 0xffff0000, v24
v_fmac_f32 v14, s77, v6
v_lshlrev_b32 v7, 16, v24
buffer_load_dwordx4 v[148:151], v58, s[36:39], s81 offen offset:2048 sc1
v_fmac_f32 v15, s77, v7
v_cvt_pk_bf16_f32 v16, v8, v9
v_cvt_pk_bf16_f32 v17, v10, v11
v_cvt_pk_bf16_f32 v20, v12, v13
v_cvt_pk_bf16_f32 v21, v14, v15
v_mov_b32 v18, s3
v_mov_b32 v19, s3
buffer_load_dwordx4 v[152:155], v58, s[36:39], s80 offen offset:3072 sc1
v_mov_b32 v22, s3
v_mov_b32 v23, s3
s_waitcnt lgkmcnt(0)
v_pk_add_f32 v[32:33], v[32:33], v[40:41]
v_pk_add_f32 v[34:35], v[34:35], v[42:43]
v_pk_add_f32 v[36:37], v[36:37], v[44:45]
v_pk_add_f32 v[38:39], v[38:39], v[46:47]
buffer_load_dwordx4 v[156:159], v58, s[36:39], s81 offen offset:3072 sc1
v_and_b32 v6, 0xffff0000, v51
v_fmac_f32 v32, s77, v6
v_lshlrev_b32 v7, 16, v51
v_fmac_f32 v33, s77, v7
v_and_b32 v6, 0xffff0000, v50
v_fmac_f32 v34, s77, v6
v_lshlrev_b32 v7, 16, v50
s_add_u32 s80, s80, 4096
s_add_u32 s81, s81, 4096
buffer_load_dwordx4 v[160:163], v58, s[36:39], s80 offen offset:0 sc1
v_fmac_f32 v35, s77, v7
v_and_b32 v6, 0xffff0000, v49
v_fmac_f32 v36, s77, v6
v_lshlrev_b32 v7, 16, v49
v_fmac_f32 v37, s77, v7
v_and_b32 v6, 0xffff0000, v48
v_fmac_f32 v38, s77, v6
buffer_load_dwordx4 v[164:167], v58, s[36:39], s81 offen offset:0 sc1
v_lshlrev_b32 v7, 16, v48
v_fmac_f32 v39, s77, v7
v_cvt_pk_bf16_f32 v40, v32, v33
v_cvt_pk_bf16_f32 v41, v34, v35
v_cvt_pk_bf16_f32 v44, v36, v37
v_cvt_pk_bf16_f32 v45, v38, v39
v_mov_b32 v42, s3
buffer_load_dwordx4 v[168:171], v58, s[36:39], s80 offen offset:1024 sc1
v_mov_b32 v43, s3
v_mov_b32 v46, s3
v_mov_b32 v47, s3
buffer_store_dwordx4 v[16:19], v4, s[36:39], s74 offen offset:0 sc1
buffer_store_dwordx4 v[20:23], v4, s[36:39], s79 offen offset:0 sc1
buffer_store_dwordx4 v[40:43], v4, s[36:39], s74 offen offset:2048 sc1
buffer_store_dwordx4 v[44:47], v4, s[36:39], s79 offen offset:2048 sc1
buffer_load_dwordx4 v[172:175], v58, s[36:39], s81 offen offset:1024 sc1
buffer_load_dwordx4 v[176:179], v58, s[36:39], s80 offen offset:2048 sc1
buffer_load_dwordx4 v[180:183], v58, s[36:39], s81 offen offset:2048 sc1
buffer_load_dwordx4 v[184:187], v58, s[36:39], s80 offen offset:3072 sc1
buffer_load_dwordx4 v[188:191], v58, s[36:39], s81 offen offset:3072 sc1
s_add_u32 s80, s80, 4096
s_add_u32 s81, s81, 4096
buffer_load_dwordx4 v[192:195], v58, s[36:39], s80 offen offset:0 sc1
buffer_load_dwordx4 v[196:199], v58, s[36:39], s81 offen offset:0 sc1
buffer_load_dwordx4 v[200:203], v58, s[36:39], s80 offen offset:1024 sc1
buffer_load_dwordx4 v[204:207], v58, s[36:39], s81 offen offset:1024 sc1
buffer_load_dwordx4 v[208:211], v58, s[36:39], s80 offen offset:2048 sc1
buffer_load_dwordx4 v[212:215], v58, s[36:39], s81 offen offset:2048 sc1
buffer_load_dwordx4 v[216:219], v58, s[36:39], s80 offen offset:3072 sc1
buffer_load_dwordx4 v[220:223], v58, s[36:39], s81 offen offset:3072 sc1
s_add_u32 s80, s80, 4096
s_add_u32 s81, s81, 4096
buffer_load_dwordx4 v[224:227], v58, s[36:39], s80 offen offset:0 sc1
buffer_load_dwordx4 v[228:231], v58, s[36:39], s81 offen offset:0 sc1
buffer_load_dwordx4 v[232:235], v58, s[36:39], s80 offen offset:1024 sc1
buffer_load_dwordx4 v[236:239], v58, s[36:39], s81 offen offset:1024 sc1
buffer_load_dwordx4 v[240:243], v58, s[36:39], s80 offen offset:2048 sc1
buffer_load_dwordx4 v[244:247], v58, s[36:39], s81 offen offset:2048 sc1
buffer_load_dwordx4 v[248:251], v58, s[36:39], s80 offen offset:3072 sc1
buffer_load_dwordx4 v[252:255], v58, s[36:39], s81 offen offset:3072 sc1
s_waitcnt vmcnt(34)
v_mfma_f32_32x32x16_bf16 v[64:79], a[0:3], v[128:131], 0
v_mfma_f32_32x32x16_bf16 v[80:95], a[4:7], v[128:131], 0
v_mfma_f32_32x32x16_bf16 v[96:111], a[0:3], v[132:135], 0
v_mfma_f32_32x32x16_bf16 v[112:127], a[4:7], v[132:135], 0
v_and_b32 v40, 63, v0
s_add_u32 s80, s80, 4096
s_add_u32 s81, s81, 4096
buffer_load_dwordx4 v[128:131], v58, s[36:39], s80 offen offset:0 sc1
v_and_b32 v41, 31, v40
v_lshrrev_b32 v42, 5, v40
s_and_b32 s74, s4, 1
s_lshr_b32 s75, s4, 1
s_lshl_b32 s76, s5, 6
s_lshl_b32 s77, s75, 5
s_add_u32 s76, s76, s77
buffer_load_dwordx4 v[132:135], v58, s[36:39], s81 offen offset:0 sc1
s_lshl_b32 s77, s6, 6
s_lshl_b32 s78, s74, 5
s_add_u32 s77, s77, s78
v_lshlrev_b32 v46, 10, v41
v_lshl_add_u32 v46, v42, 3, v46
s_lshl_b32 s82, s76, 10
s_lshl_b32 s83, s77, 1
s_add_u32 s82, s82, s83
v_lshlrev_b32 v47, 3, v42
v_lshrrev_b32 v43, 2, v40
v_and_b32 v44, 3, v40
v_lshlrev_b32 v45, 13, v43
v_lshl_add_u32 v45, v44, 4, v45
v_add_u32 v44, 4096, v45
s_lshl_b32 s84, s77, 13
s_lshl_b32 s85, s76, 1
s_add_u32 s84, s84, s85
s_add_u32 s84, s84, 25165824
s_add_u32 s85, s84, 131072
v_lshlrev_b32 v48, 3, v41
s_lshl_b32 s86, s76, 3
s_add_u32 s86, s86, 131072
s_waitcnt vmcnt(34)
v_mfma_f32_32x32x16_bf16 v[64:79], a[8:11], v[136:139], v[64:79]
v_mfma_f32_32x32x16_bf16 v[80:95], a[12:15], v[136:139], v[80:95]
v_mfma_f32_32x32x16_bf16 v[96:111], a[8:11], v[140:143], v[96:111]
v_mfma_f32_32x32x16_bf16 v[112:127], a[12:15], v[140:143], v[112:127]
s_waitcnt vmcnt(32)
buffer_load_dwordx4 v[136:139], v58, s[36:39], s80 offen offset:1024 sc1
v_mfma_f32_32x32x16_bf16 v[64:79], a[16:19], v[144:147], v[64:79]
buffer_load_dwordx4 v[140:143], v58, s[36:39], s81 offen offset:1024 sc1
v_mfma_f32_32x32x16_bf16 v[80:95], a[20:23], v[144:147], v[80:95]
v_mfma_f32_32x32x16_bf16 v[96:111], a[16:19], v[148:151], v[96:111]
v_mfma_f32_32x32x16_bf16 v[112:127], a[20:23], v[148:151], v[112:127]
s_waitcnt vmcnt(32)
buffer_load_dwordx4 v[144:147], v58, s[36:39], s80 offen offset:2048 sc1
v_mfma_f32_32x32x16_bf16 v[64:79], a[24:27], v[152:155], v[64:79]
buffer_load_dwordx4 v[148:151], v58, s[36:39], s81 offen offset:2048 sc1
v_mfma_f32_32x32x16_bf16 v[80:95], a[28:31], v[152:155], v[80:95]
v_mfma_f32_32x32x16_bf16 v[96:111], a[24:27], v[156:159], v[96:111]
v_mfma_f32_32x32x16_bf16 v[112:127], a[28:31], v[156:159], v[112:127]
s_waitcnt vmcnt(32)
buffer_load_dwordx4 v[152:155], v58, s[36:39], s80 offen offset:3072 sc1
v_mfma_f32_32x32x16_bf16 v[64:79], a[32:35], v[160:163], v[64:79]
buffer_load_dwordx4 v[156:159], v58, s[36:39], s81 offen offset:3072 sc1
v_mfma_f32_32x32x16_bf16 v[80:95], a[36:39], v[160:163], v[80:95]
v_mfma_f32_32x32x16_bf16 v[96:111], a[32:35], v[164:167], v[96:111]
v_mfma_f32_32x32x16_bf16 v[112:127], a[36:39], v[164:167], v[112:127]
s_waitcnt vmcnt(28)
s_add_u32 s80, s80, 4096
s_add_u32 s81, s81, 4096
buffer_load_dwordx4 v[160:163], v58, s[36:39], s80 offen offset:0 sc1
v_mfma_f32_32x32x16_bf16 v[64:79], a[40:43], v[168:171], v[64:79]
buffer_load_dwordx4 v[164:167], v58, s[36:39], s81 offen offset:0 sc1
v_mfma_f32_32x32x16_bf16 v[80:95], a[44:47], v[168:171], v[80:95]
v_mfma_f32_32x32x16_bf16 v[96:111], a[40:43], v[172:175], v[96:111]
v_mfma_f32_32x32x16_bf16 v[112:127], a[44:47], v[172:175], v[112:127]
s_waitcnt vmcnt(28)
buffer_load_dwordx4 v[168:171], v58, s[36:39], s80 offen offset:1024 sc1
v_mfma_f32_32x32x16_bf16 v[64:79], a[48:51], v[176:179], v[64:79]
buffer_load_dwordx4 v[172:175], v58, s[36:39], s81 offen offset:1024 sc1
v_mfma_f32_32x32x16_bf16 v[80:95], a[52:55], v[176:179], v[80:95]
v_mfma_f32_32x32x16_bf16 v[96:111], a[48:51], v[180:183], v[96:111]
v_mfma_f32_32x32x16_bf16 v[112:127], a[52:55], v[180:183], v[112:127]
s_waitcnt vmcnt(28)
buffer_load_dwordx4 v[176:179], v58, s[36:39], s80 offen offset:2048 sc1
v_mfma_f32_32x32x16_bf16 v[64:79], a[56:59], v[184:187], v[64:79]
buffer_load_dwordx4 v[180:183], v58, s[36:39], s81 offen offset:2048 sc1
v_mfma_f32_32x32x16_bf16 v[80:95], a[60:63], v[184:187], v[80:95]
v_mfma_f32_32x32x16_bf16 v[96:111], a[56:59], v[188:191], v[96:111]
v_mfma_f32_32x32x16_bf16 v[112:127], a[60:63], v[188:191], v[112:127]
s_waitcnt vmcnt(28)
buffer_load_dwordx4 v[184:187], v58, s[36:39], s80 offen offset:3072 sc1
v_mfma_f32_32x32x16_bf16 v[64:79], a[64:67], v[192:195], v[64:79]
buffer_load_dwordx4 v[188:191], v58, s[36:39], s81 offen offset:3072 sc1
v_mfma_f32_32x32x16_bf16 v[80:95], a[68:71], v[192:195], v[80:95]
buffer_load_dwordx2 v[8:9], v46, s[8:11], s82 offen offset:0
v_mfma_f32_32x32x16_bf16 v[96:111], a[64:67], v[196:199], v[96:111]
v_mfma_f32_32x32x16_bf16 v[112:127], a[68:71], v[196:199], v[112:127]
s_waitcnt vmcnt(29)
v_mfma_f32_32x32x16_bf16 v[64:79], a[72:75], v[200:203], v[64:79]
v_mfma_f32_32x32x16_bf16 v[80:95], a[76:79], v[200:203], v[80:95]
v_mfma_f32_32x32x16_bf16 v[96:111], a[72:75], v[204:207], v[96:111]
v_mfma_f32_32x32x16_bf16 v[112:127], a[76:79], v[204:207], v[112:127]
buffer_load_dwordx2 v[10:11], v46, s[8:11], s82 offen offset:16
s_waitcnt vmcnt(28)
v_mfma_f32_32x32x16_bf16 v[64:79], a[80:83], v[208:211], v[64:79]
v_mfma_f32_32x32x16_bf16 v[80:95], a[84:87], v[208:211], v[80:95]
v_mfma_f32_32x32x16_bf16 v[96:111], a[80:83], v[212:215], v[96:111]
v_mfma_f32_32x32x16_bf16 v[112:127], a[84:87], v[212:215], v[112:127]
s_waitcnt vmcnt(26)
v_mfma_f32_32x32x16_bf16 v[64:79], a[88:91], v[216:219], v[64:79]
buffer_load_dwordx2 v[12:13], v46, s[8:11], s82 offen offset:32
v_mfma_f32_32x32x16_bf16 v[80:95], a[92:95], v[216:219], v[80:95]
v_mfma_f32_32x32x16_bf16 v[96:111], a[88:91], v[220:223], v[96:111]
v_mfma_f32_32x32x16_bf16 v[112:127], a[92:95], v[220:223], v[112:127]
s_waitcnt vmcnt(25)
v_mfma_f32_32x32x16_bf16 v[64:79], a[96:99], v[224:227], v[64:79]
v_mfma_f32_32x32x16_bf16 v[80:95], a[100:103], v[224:227], v[80:95]
v_mfma_f32_32x32x16_bf16 v[96:111], a[96:99], v[228:231], v[96:111]
buffer_load_dwordx2 v[14:15], v46, s[8:11], s82 offen offset:48
v_mfma_f32_32x32x16_bf16 v[112:127], a[100:103], v[228:231], v[112:127]
s_waitcnt vmcnt(24)
v_mfma_f32_32x32x16_bf16 v[64:79], a[104:107], v[232:235], v[64:79]
v_mfma_f32_32x32x16_bf16 v[80:95], a[108:111], v[232:235], v[80:95]
v_mfma_f32_32x32x16_bf16 v[96:111], a[104:107], v[236:239], v[96:111]
v_mfma_f32_32x32x16_bf16 v[112:127], a[108:111], v[236:239], v[112:127]
s_waitcnt vmcnt(22)
v_mfma_f32_32x32x16_bf16 v[64:79], a[112:115], v[240:243], v[64:79]
s_mov_b32 s40, s64
s_mov_b32 s41, s65
s_mov_b32 s42, 1024
buffer_load_dwordx2 v[16:17], v47, s[40:43], s83 offen offset:0
v_mfma_f32_32x32x16_bf16 v[80:95], a[116:119], v[240:243], v[80:95]
buffer_load_dwordx2 v[18:19], v47, s[40:43], s83 offen offset:16
v_mfma_f32_32x32x16_bf16 v[96:111], a[112:115], v[244:247], v[96:111]
buffer_load_dwordx2 v[20:21], v47, s[40:43], s83 offen offset:32
v_mfma_f32_32x32x16_bf16 v[112:127], a[116:119], v[244:247], v[112:127]
buffer_load_dwordx2 v[22:23], v47, s[40:43], s83 offen offset:48
s_waitcnt vmcnt(24)
v_mfma_f32_32x32x16_bf16 v[64:79], a[120:123], v[248:251], v[64:79]
s_add_u32 s80, s80, 4096
s_add_u32 s81, s81, 4096
buffer_load_dwordx4 v[192:195], v58, s[36:39], s80 offen offset:0 sc1
v_mfma_f32_32x32x16_bf16 v[80:95], a[124:127], v[248:251], v[80:95]
buffer_load_dwordx4 v[196:199], v58, s[36:39], s81 offen offset:0 sc1
v_mfma_f32_32x32x16_bf16 v[96:111], a[120:123], v[252:255], v[96:111]
buffer_load_dwordx4 v[200:203], v58, s[36:39], s80 offen offset:1024 sc1
v_mfma_f32_32x32x16_bf16 v[112:127], a[124:127], v[252:255], v[112:127]
buffer_load_dwordx4 v[204:207], v58, s[36:39], s81 offen offset:1024 sc1
s_waitcnt vmcnt(26)
v_mfma_f32_32x32x16_bf16 v[64:79], a[128:131], v[128:131], v[64:79]
buffer_load_dwordx4 v[208:211], v58, s[36:39], s80 offen offset:2048 sc1
v_mfma_f32_32x32x16_bf16 v[80:95], a[132:135], v[128:131], v[80:95]
buffer_load_dwordx4 v[212:215], v58, s[36:39], s81 offen offset:2048 sc1
v_mfma_f32_32x32x16_bf16 v[96:111], a[128:131], v[132:135], v[96:111]
buffer_load_dwordx4 v[216:219], v58, s[36:39], s80 offen offset:3072 sc1
v_mfma_f32_32x32x16_bf16 v[112:127], a[132:135], v[132:135], v[112:127]
buffer_load_dwordx4 v[220:223], v58, s[36:39], s81 offen offset:3072 sc1
s_waitcnt vmcnt(28)
v_mfma_f32_32x32x16_bf16 v[64:79], a[136:139], v[136:139], v[64:79]
v_mfma_f32_32x32x16_bf16 v[80:95], a[140:143], v[136:139], v[80:95]
v_mfma_f32_32x32x16_bf16 v[96:111], a[136:139], v[140:143], v[96:111]
v_mfma_f32_32x32x16_bf16 v[112:127], a[140:143], v[140:143], v[112:127]
s_waitcnt vmcnt(26)
v_mfma_f32_32x32x16_bf16 v[64:79], a[144:147], v[144:147], v[64:79]
v_mfma_f32_32x32x16_bf16 v[80:95], a[148:151], v[144:147], v[80:95]
v_mfma_f32_32x32x16_bf16 v[96:111], a[144:147], v[148:151], v[96:111]
v_mfma_f32_32x32x16_bf16 v[112:127], a[148:151], v[148:151], v[112:127]
s_waitcnt vmcnt(24)
v_mfma_f32_32x32x16_bf16 v[64:79], a[152:155], v[152:155], v[64:79]
v_mfma_f32_32x32x16_bf16 v[80:95], a[156:159], v[152:155], v[80:95]
v_mfma_f32_32x32x16_bf16 v[96:111], a[152:155], v[156:159], v[96:111]
v_mfma_f32_32x32x16_bf16 v[112:127], a[156:159], v[156:159], v[112:127]
s_waitcnt vmcnt(22)
v_mfma_f32_32x32x16_bf16 v[64:79], a[160:163], v[160:163], v[64:79]
v_mfma_f32_32x32x16_bf16 v[80:95], a[164:167], v[160:163], v[80:95]
v_mfma_f32_32x32x16_bf16 v[96:111], a[160:163], v[164:167], v[96:111]
v_mfma_f32_32x32x16_bf16 v[112:127], a[164:167], v[164:167], v[112:127]
s_waitcnt vmcnt(20)
v_mfma_f32_32x32x16_bf16 v[64:79], a[168:171], v[168:171], v[64:79]
v_mfma_f32_32x32x16_bf16 v[80:95], a[172:175], v[168:171], v[80:95]
v_mfma_f32_32x32x16_bf16 v[96:111], a[168:171], v[172:175], v[96:111]
v_mfma_f32_32x32x16_bf16 v[112:127], a[172:175], v[172:175], v[112:127]
s_waitcnt vmcnt(18)
v_mfma_f32_32x32x16_bf16 v[64:79], a[176:179], v[176:179], v[64:79]
v_mfma_f32_32x32x16_bf16 v[80:95], a[180:183], v[176:179], v[80:95]
v_mfma_f32_32x32x16_bf16 v[96:111], a[176:179], v[180:183], v[96:111]
v_mfma_f32_32x32x16_bf16 v[112:127], a[180:183], v[180:183], v[112:127]
s_waitcnt vmcnt(16)
buffer_load_dwordx2 v[32:33], v48, s[36:39], s86 offen sc1
buffer_load_dwordx4 v[224:227], v45, s[36:39], s84 offen sc1
v_mfma_f32_32x32x16_bf16 v[64:79], a[184:187], v[184:187], v[64:79]
v_mfma_f32_32x32x16_bf16 v[80:95], a[188:191], v[184:187], v[80:95]
buffer_load_dwordx4 v[228:231], v44, s[36:39], s84 offen sc1
v_mfma_f32_32x32x16_bf16 v[96:111], a[184:187], v[188:191], v[96:111]
v_mfma_f32_32x32x16_bf16 v[112:127], a[188:191], v[188:191], v[112:127]
buffer_load_dwordx4 v[232:235], v45, s[36:39], s85 offen sc1
v_lshlrev_b32 v49, 4, v40
s_xor_b32 s74, s4, 1
s_mul_i32 s74, s74, 12288
v_add_u32 v53, s74, v49
s_xor_b32 s74, s4, 2
s_mul_i32 s74, s74, 12288
v_add_u32 v54, s74, v49
s_xor_b32 s74, s4, 3
s_mul_i32 s74, s74, 12288
v_add_u32 v55, s74, v49
s_waitcnt vmcnt(10)
v_mfma_f32_32x32x16_bf16 v[80:95], a[196:199], v[192:195], v[80:95]
buffer_load_dwordx4 v[236:239], v44, s[36:39], s85 offen sc1
s_waitcnt vmcnt(9)
v_mfma_f32_32x32x16_bf16 v[80:95], a[204:207], v[200:203], v[80:95]
s_waitcnt vmcnt(7)
v_mfma_f32_32x32x16_bf16 v[80:95], a[212:215], v[208:211], v[80:95]
s_waitcnt vmcnt(5)
v_mfma_f32_32x32x16_bf16 v[80:95], a[220:223], v[216:219], v[80:95]
v_mfma_f32_32x32x16_bf16 v[96:111], a[192:195], v[196:199], v[96:111]
v_mfma_f32_32x32x16_bf16 v[96:111], a[200:203], v[204:207], v[96:111]
v_mfma_f32_32x32x16_bf16 v[96:111], a[208:211], v[212:215], v[96:111]
v_mfma_f32_32x32x16_bf16 v[96:111], a[216:219], v[220:223], v[96:111]
v_mfma_f32_32x32x16_bf16 v[112:127], a[196:199], v[196:199], v[112:127]
s_nop 6
ds_write_b128 v53, v[80:83] offset:0
v_mfma_f32_32x32x16_bf16 v[112:127], a[204:207], v[204:207], v[112:127]
ds_write_b128 v53, v[84:87] offset:1024
v_mfma_f32_32x32x16_bf16 v[112:127], a[212:215], v[212:215], v[112:127]
ds_write_b128 v53, v[88:91] offset:2048
v_mfma_f32_32x32x16_bf16 v[112:127], a[220:223], v[220:223], v[112:127]
ds_write_b128 v53, v[92:95] offset:3072
v_mfma_f32_32x32x16_bf16 v[64:79], a[192:195], v[192:195], v[64:79]
ds_write_b128 v54, v[96:99] offset:4096
v_mfma_f32_32x32x16_bf16 v[64:79], a[200:203], v[200:203], v[64:79]
ds_write_b128 v54, v[100:103] offset:5120
v_mfma_f32_32x32x16_bf16 v[64:79], a[208:211], v[208:211], v[64:79]
ds_write_b128 v54, v[104:107] offset:6144
v_mfma_f32_32x32x16_bf16 v[64:79], a[216:219], v[216:219], v[64:79]
ds_write_b128 v54, v[108:111] offset:7168
s_nop 2
ds_write_b128 v55, v[112:115] offset:8192
ds_write_b128 v55, v[116:119] offset:9216
ds_write_b128 v55, v[120:123] offset:10240
ds_write_b128 v55, v[124:127] offset:11264
v_lshlrev_b32 v49, 4, v40
s_lshl_b32 s80, s4, 11
s_add_u32 s80, s80, 49152
v_add_u32 v51, s80, v49
s_waitcnt vmcnt(0)
v_cmp_ne_u32 vcc, s3, v33
v_cmp_ne_u32 s[80:81], s3, v226
s_or_b64 vcc, vcc, s[80:81]
v_cmp_ne_u32 s[80:81], s3, v230
s_or_b64 vcc, vcc, s[80:81]
v_cmp_ne_u32 s[80:81], s3, v234
s_or_b64 vcc, vcc, s[80:81]
v_cmp_ne_u32 s[80:81], s3, v238
s_or_b64 vcc, vcc, s[80:81]
s_cbranch_vccz YOK_13
s_mov_b32 s101, 32768
YRT_14:
s_sleep 1
buffer_load_dwordx2 v[32:33], v48, s[36:39], s86 offen sc1
buffer_load_dwordx4 v[224:227], v45, s[36:39], s84 offen sc1
buffer_load_dwordx4 v[228:231], v44, s[36:39], s84 offen sc1
buffer_load_dwordx4 v[232:235], v45, s[36:39], s85 offen sc1
buffer_load_dwordx4 v[236:239], v44, s[36:39], s85 offen sc1
s_waitcnt vmcnt(0)
v_cmp_ne_u32 vcc, s3, v33
v_cmp_ne_u32 s[80:81], s3, v226
s_or_b64 vcc, vcc, s[80:81]
v_cmp_ne_u32 s[80:81], s3, v230
s_or_b64 vcc, vcc, s[80:81]
v_cmp_ne_u32 s[80:81], s3, v234
s_or_b64 vcc, vcc, s[80:81]
v_cmp_ne_u32 s[80:81], s3, v238
s_or_b64 vcc, vcc, s[80:81]
s_cbranch_vccz YOK_13
s_sub_u32 s101, s101, 1
s_cbranch_scc0 YRT_14
YOK_13:
ds_write_b64 v51, v[224:225] offset:0
ds_write_b64 v51, v[228:229] offset:8
ds_write_b64 v51, v[232:233] offset:1024
ds_write_b64 v51, v[236:237] offset:1032
s_waitcnt lgkmcnt(0)
s_barrier
s_mul_i32 s80, s4, 12288
v_add_u32 v50, s80, v49
ds_read_b128 v[160:163], v50 offset:0
ds_read_b128 v[164:167], v50 offset:1024
ds_read_b128 v[168:171], v50 offset:2048
ds_read_b128 v[172:175], v50 offset:3072
ds_read_b128 v[176:179], v50 offset:4096
ds_read_b128 v[180:183], v50 offset:5120
ds_read_b128 v[184:187], v50 offset:6144
ds_read_b128 v[188:191], v50 offset:7168
ds_read_b128 v[192:195], v50 offset:8192
ds_read_b128 v[196:199], v50 offset:9216
ds_read_b128 v[200:203], v50 offset:10240
ds_read_b128 v[204:207], v50 offset:11264
v_and_b32 v52, 15, v40
v_lshrrev_b32 v53, 2, v52
v_lshl_add_u32 v53, v42, 2, v53
v_lshlrev_b32 v53, 6, v53
v_bfe_u32 v54, v40, 4, 1
v_lshl_add_u32 v53, v54, 5, v53
v_and_b32 v54, 3, v52
v_lshl_add_u32 v53, v54, 3, v53
s_lshl_b32 s80, s4, 11
s_add_u32 s80, s80, 49152
v_add_u32 v53, s80, v53
ds_read_b64_tr_b16 v[208:209], v53 offset:0
ds_read_b64_tr_b16 v[210:211], v53 offset:512
ds_read_b64_tr_b16 v[212:213], v53 offset:1024
ds_read_b64_tr_b16 v[214:215], v53 offset:1536
s_waitcnt lgkmcnt(12)
v_pk_add_f32 v[64:65], v[64:65], v[160:161]
v_pk_add_f32 v[66:67], v[66:67], v[162:163]
v_pk_add_f32 v[68:69], v[68:69], v[164:165]
v_pk_add_f32 v[70:71], v[70:71], v[166:167]
v_pk_add_f32 v[72:73], v[72:73], v[168:169]
v_pk_add_f32 v[74:75], v[74:75], v[170:171]
v_pk_add_f32 v[76:77], v[76:77], v[172:173]
v_pk_add_f32 v[78:79], v[78:79], v[174:175]
s_waitcnt lgkmcnt(8)
v_pk_add_f32 v[64:65], v[64:65], v[176:177]
v_pk_add_f32 v[66:67], v[66:67], v[178:179]
v_pk_add_f32 v[68:69], v[68:69], v[180:181]
v_pk_add_f32 v[70:71], v[70:71], v[182:183]
v_pk_add_f32 v[72:73], v[72:73], v[184:185]
v_pk_add_f32 v[74:75], v[74:75], v[186:187]
v_pk_add_f32 v[76:77], v[76:77], v[188:189]
v_pk_add_f32 v[78:79], v[78:79], v[190:191]
s_waitcnt lgkmcnt(4)
v_pk_add_f32 v[64:65], v[64:65], v[192:193]
v_pk_add_f32 v[66:67], v[66:67], v[194:195]
v_pk_add_f32 v[68:69], v[68:69], v[196:197]
v_pk_add_f32 v[70:71], v[70:71], v[198:199]
v_pk_add_f32 v[72:73], v[72:73], v[200:201]
v_pk_add_f32 v[74:75], v[74:75], v[202:203]
v_pk_add_f32 v[76:77], v[76:77], v[204:205]
v_pk_add_f32 v[78:79], v[78:79], v[206:207]
s_waitcnt lgkmcnt(0)
v_lshlrev_b32 v128, 16, v16
v_lshlrev_b32 v132, 16, v8
v_lshlrev_b32 v136, 16, v208
v_and_b32 v129, 0xffff0000, v16
v_and_b32 v133, 0xffff0000, v8
v_and_b32 v137, 0xffff0000, v208
v_lshlrev_b32 v130, 16, v17
v_lshlrev_b32 v134, 16, v9
v_lshlrev_b32 v138, 16, v209
v_and_b32 v131, 0xffff0000, v17
v_and_b32 v135, 0xffff0000, v9
v_and_b32 v139, 0xffff0000, v209
v_add_f32 v64, v64, v128
v_add_f32 v65, v65, v129
v_add_f32 v66, v66, v130
v_add_f32 v67, v67, v131
v_fma_f32 v132, v132, v136, -v64
v_fma_f32 v133, v133, v137, -v65
v_fma_f32 v134, v134, v138, -v66
v_fma_f32 v135, v135, v139, -v67
v_fmac_f32 v64, v32, v132
v_fmac_f32 v65, v32, v133
v_fmac_f32 v66, v32, v134
v_fmac_f32 v67, v32, v135
v_cvt_pk_bf16_f32 v224, v64, v65
v_cvt_pk_bf16_f32 v225, v66, v67
v_lshlrev_b32 v128, 16, v18
v_lshlrev_b32 v132, 16, v10
v_lshlrev_b32 v136, 16, v210
v_and_b32 v129, 0xffff0000, v18
v_and_b32 v133, 0xffff0000, v10
v_and_b32 v137, 0xffff0000, v210
v_lshlrev_b32 v130, 16, v19
v_lshlrev_b32 v134, 16, v11
v_lshlrev_b32 v138, 16, v211
v_and_b32 v131, 0xffff0000, v19
v_and_b32 v135, 0xffff0000, v11
v_and_b32 v139, 0xffff0000, v211
v_add_f32 v68, v68, v128
v_add_f32 v69, v69, v129
v_add_f32 v70, v70, v130
v_add_f32 v71, v71, v131
v_fma_f32 v132, v132, v136, -v68
v_fma_f32 v133, v133, v137, -v69
v_fma_f32 v134, v134, v138, -v70
v_fma_f32 v135, v135, v139, -v71
v_fmac_f32 v68, v32, v132
v_fmac_f32 v69, v32, v133
v_fmac_f32 v70, v32, v134
v_fmac_f32 v71, v32, v135
v_cvt_pk_bf16_f32 v228, v68, v69
v_cvt_pk_bf16_f32 v229, v70, v71
v_lshlrev_b32 v128, 16, v20
v_lshlrev_b32 v132, 16, v12
v_lshlrev_b32 v136, 16, v212
v_and_b32 v129, 0xffff0000, v20
v_and_b32 v133, 0xffff0000, v12
v_and_b32 v137, 0xffff0000, v212
v_lshlrev_b32 v130, 16, v21
v_lshlrev_b32 v134, 16, v13
v_lshlrev_b32 v138, 16, v213
v_and_b32 v131, 0xffff0000, v21
v_and_b32 v135, 0xffff0000, v13
v_and_b32 v139, 0xffff0000, v213
v_add_f32 v72, v72, v128
v_add_f32 v73, v73, v129
v_add_f32 v74, v74, v130
v_add_f32 v75, v75, v131
v_fma_f32 v132, v132, v136, -v72
v_fma_f32 v133, v133, v137, -v73
v_fma_f32 v134, v134, v138, -v74
v_fma_f32 v135, v135, v139, -v75
v_fmac_f32 v72, v32, v132
v_fmac_f32 v73, v32, v133
v_fmac_f32 v74, v32, v134
v_fmac_f32 v75, v32, v135
v_cvt_pk_bf16_f32 v226, v72, v73
v_cvt_pk_bf16_f32 v227, v74, v75
v_lshlrev_b32 v128, 16, v22
v_lshlrev_b32 v132, 16, v14
v_lshlrev_b32 v136, 16, v214
v_and_b32 v129, 0xffff0000, v22
v_and_b32 v133, 0xffff0000, v14
v_and_b32 v137, 0xffff0000, v214
v_lshlrev_b32 v130, 16, v23
v_lshlrev_b32 v134, 16, v15
v_lshlrev_b32 v138, 16, v215
v_and_b32 v131, 0xffff0000, v23
v_and_b32 v135, 0xffff0000, v15
v_and_b32 v139, 0xffff0000, v215
v_add_f32 v76, v76, v128
v_add_f32 v77, v77, v129
v_add_f32 v78, v78, v130
v_add_f32 v79, v79, v131
v_fma_f32 v132, v132, v136, -v76
v_fma_f32 v133, v133, v137, -v77
v_fma_f32 v134, v134, v138, -v78
v_fma_f32 v135, v135, v139, -v79
v_fmac_f32 v76, v32, v132
v_fmac_f32 v77, v32, v133
v_fmac_f32 v78, v32, v134
v_fmac_f32 v79, v32, v135
v_cvt_pk_bf16_f32 v230, v76, v77
v_cvt_pk_bf16_f32 v231, v78, v79
v_permlane32_swap_b32 v224, v226
v_permlane32_swap_b32 v225, v227
v_permlane32_swap_b32 v228, v230
v_permlane32_swap_b32 v229, v231
v_lshlrev_b32 v46, 10, v41
v_lshl_add_u32 v46, v42, 5, v46
buffer_store_dwordx4 v[224:227], v46, s[32:35], s82 offen
buffer_store_dwordx4 v[228:231], v46, s[32:35], s82 offen offset:16
s_or_b32 s74, s2, s4
s_cmp_eq_u32 s74, 0
s_cbranch_scc0 NOEP
s_add_u32 s96, s96, 1
v_mov_b32 v62, s96
s_mov_b32 s97, 98304
s_mov_b64 exec, 1
buffer_store_dword v62, off, s[36:39], s97
s_mov_b64 exec, -1
NOEP:
s_waitcnt vmcnt(0) lgkmcnt(0)
s_waitcnt vmcnt(0)
K_END:
s_endpgm
K_CODE_END:
.section .rodata,"a"
.p2align 6
.amdhsa_kernel gated_mix__ssm_conv_h3__dense_activation_squared_relu__prompt_kernel
  .amdhsa_next_free_vgpr 512
  .amdhsa_next_free_sgpr 102
  .amdhsa_accum_offset 256
  .amdhsa_group_segment_fixed_size 0
  .amdhsa_kernarg_size 120
  .amdhsa_user_sgpr_count 2
  .amdhsa_user_sgpr_kernarg_segment_ptr 1
  .amdhsa_system_sgpr_workgroup_id_x 1
.end_amdhsa_kernel
```
